```python
import torch

def _softmax(x, axis=-1):
    return torch.softmax(x, dim=axis)
def _gelu(x):
    return torch.nn.functional.gelu(x, approximate="tanh")
def _silu(x):
    return torch.nn.functional.silu(x)
def _sigmoid(x):
    return torch.sigmoid(x)
def _layernorm(x, axis=-1, eps=1e-5):
    m = x.mean(dim=axis, keepdim=True)
    v = x.var(dim=axis, keepdim=True, unbiased=False)
    return (x - m) / torch.sqrt(v + eps)
def _scatter_add(tgt, idx, src, axis=0):
    return tgt.clone().index_add_(axis, idx, src)
def _segment_sum(src, seg, n):
    out = torch.zeros((n,) + src.shape[1:], dtype=src.dtype)
    return out.index_add_(0, seg, src)
def _pad(x, pw):
    flat = tuple(v for pair in reversed(pw) for v in pair)
    return torch.nn.functional.pad(x, flat)

kernel_name = 'standalone__deep_cross_wide_deep__recsys'

def setup_inputs():

    _w = (lambda a: (lambda t: t.to(torch.bfloat16) if t.is_floating_point() else t)(torch.as_tensor(a)))
    B, F, D = 4096, 100, 64
    V, Nd = min(100000, 100000), 13
    Din = F * D
    H = 4 * D
    return {
        "idx": _w((lambda lo, hi, *s: torch.randint(lo, hi, s))(0, V, B, F).to(torch.int64)),
        "table": _w((lambda *s: torch.randn(*s, dtype=torch.bfloat16) * 1.6)(V, D) * 0.05),
        "x_wide": _w((lambda *s: torch.randn(*s, dtype=torch.bfloat16) * 1.6)(B, Nd)),
        "w_wide": _w((lambda *s: torch.randn(*s, dtype=torch.bfloat16) * 1.6)(Nd) * 0.05),
        "b_wide": _w((lambda *s: torch.randn(*s, dtype=torch.bfloat16) * 1.6)(1) * 0.01),
        "W1": _w((lambda *s: torch.randn(*s, dtype=torch.bfloat16) * 1.6)(Din, H) * (2.0 / Din) ** 0.5),
        "b1": _w((lambda *s: torch.randn(*s, dtype=torch.bfloat16) * 1.6)(H) * 0.01),
        "W2": _w((lambda *s: torch.randn(*s, dtype=torch.bfloat16) * 1.6)(H) * (1.0 / H) ** 0.5),
        "b2": _w((lambda *s: torch.randn(*s, dtype=torch.bfloat16) * 1.6)(1) * 0.01),
    }

def reference(idx, table, x_wide, w_wide, b_wide, W1, b1, W2, b2):
    emb = table[idx]
    deep_in = emb.reshape(emb.shape[0], -1)
    h = deep_in @ W1 + b1
    h = h * (lambda x, dt: x.to(dt))(h > 0, h.dtype)
    deep_logit = h @ W2 + b2
    wide_logit = x_wide @ w_wide + b_wide
    return _sigmoid(wide_logit + deep_logit)
```

```asm
; @launch grid=(256,1,1) block=(512,1,1) lds=163840
.amdgcn_target "amdgcn-amd-amdhsa--gfx950"
.text
.globl standalone__deep_cross_wide_deep__recsys_kernel
.p2align 8
.type standalone__deep_cross_wide_deep__recsys_kernel,@function
standalone__deep_cross_wide_deep__recsys_kernel:
    s_cmp_ge_u32 s2, 256
    s_cbranch_scc1 L_end
    s_load_dwordx16 s[4:19], s[0:1], 0
    s_load_dwordx8 s[20:27], s[0:1], 64
    v_lshrrev_b32 v2, 6, v0
    v_and_b32 v1, 63, v0
    v_readfirstlane_b32 s52, v2
    s_lshr_b32 s59, s2, 3
    s_and_b32 s68, s59, 1
    s_lshr_b32 s53, s59, 1
    s_bfe_u32 s60, s2, 0x10002
    s_lshl_b32 s60, s60, 4
    s_add_u32 s53, s53, s60
    s_and_b32 s70, s2, 3
    s_lshl_b32 s54, s68, 2
    s_add_u32 s54, s54, s70
    s_lshl_b32 s66, s53, 3
    s_add_u32 s63, s66, s54
    s_and_b32 s55, s52, 3
    s_cmp_lt_u32 s52, 4
    s_cbranch_scc1 L_compute
    s_setprio 2
    s_mul_i32 s69, s70, 25
    s_lshl_b32 s94, s69, 15
    s_lshl_b32 s59, s68, 16
    s_add_u32 s57, s94, s59
    s_sub_u32 s58, s94, s59
    s_lshl_b32 s69, s69, 2
    s_lshl_b32 s56, s55, 12
    s_mul_i32 s100, s53, 43
    s_lshr_b32 s100, s100, 8
    s_mul_i32 s100, s100, 6
    s_sub_u32 s100, s53, s100
    s_lshl_b32 s100, s100, 17
    v_lshrrev_b32 v4, 3, v1
    s_lshl_b32 s59, s55, 1
    s_add_u32 s59, s59, s54
    s_add_u32 s59, s59, 1
    s_and_b32 s59, s59, 7
    s_add_u32 s59, s59, s66
    s_lshl_b32 s59, s59, 4
    v_add_u32 v2, s59, v4
    v_mul_u32_u24 v2, 400, v2
    s_lshl_b32 s59, s55, 1
    s_add_u32 s59, s59, s54
    s_add_u32 s59, s59, 2
    s_and_b32 s59, s59, 7
    s_add_u32 s59, s59, s66
    s_lshl_b32 s59, s59, 4
    v_add_u32 v3, s59, v4
    v_mul_u32_u24 v3, 400, v3
    v_and_b32 v10, 7, v1
    v_lshl_add_u32 v2, v10, 4, v2
    v_lshl_add_u32 v3, v10, 4, v3
    v_add_u32 v156, 3200, v2
    v_add_u32 v157, 3200, v3
    v_lshrrev_b32 v4, 4, v1
    v_lshlrev_b32 v5, 1, v4
    v_and_b32 v10, 15, v1
    v_xor_b32 v5, v5, v10
    v_lshlrev_b32 v4, 9, v4
    s_lshl_b32 s59, s55, 13
    s_lshl_b32 s60, s68, 8
    s_add_u32 s59, s59, s60
    v_add_u32 v4, s59, v4
    v_lshl_add_u32 v6, v5, 4, v4
    v_add_u32 v7, 2048, v6
    v_xor_b32 v5, 8, v5
    v_lshl_add_u32 v8, v5, 4, v4
    v_add_u32 v8, 4096, v8
    v_add_u32 v9, 2048, v8
    s_waitcnt lgkmcnt(0)
    s_mov_b32 s36, s4
    s_and_b32 s37, s5, 0xffff
    s_mov_b32 s38, 0x190000
    s_mov_b32 s39, 0x00020000
    s_mov_b32 s32, s14
    s_and_b32 s33, s15, 0xffff
    s_mov_b32 s34, 0x320000
    s_mov_b32 s35, 0x00020000
    s_add_u32 m0, s56, 0x24000
    s_nop 0
    buffer_load_dwordx4 v2, s[36:39], s69 offen lds
    s_add_u32 m0, s56, 0x24400
    s_nop 0
    buffer_load_dwordx4 v156, s[36:39], s69 offen lds
    s_add_u32 m0, s56, 0x24800
    s_nop 0
    buffer_load_dwordx4 v3, s[36:39], s69 offen lds
    s_add_u32 m0, s56, 0x24c00
    s_nop 0
    buffer_load_dwordx4 v157, s[36:39], s69 offen lds
    s_add_u32 s62, s94, 0xc0000
    s_add_u32 m0, s56, 0x0
    s_nop 0
    buffer_load_dwordx4 v6, s[32:35], s62 offen lds
    s_add_u32 m0, s56, 0x400
    s_nop 0
    buffer_load_dwordx4 v7, s[32:35], s62 offen lds
    s_add_u32 m0, s56, 0x800
    s_nop 0
    buffer_load_dwordx4 v8, s[32:35], s62 offen lds
    s_add_u32 m0, s56, 0xc00
    s_nop 0
    buffer_load_dwordx4 v9, s[32:35], s62 offen lds
    s_mov_b32 s28, s6
    s_and_b32 s29, s7, 0xffff
    s_mov_b32 s30, 0xc35000
    s_mov_b32 s31, 0x00020000
    s_mov_b32 s40, s26
    s_and_b32 s41, s27, 0xffff
    s_mov_b32 s42, 0x4000000
    s_mov_b32 s43, 0x00020000
    s_mov_b32 s44, s24
    s_and_b32 s45, s25, 0xffff
    s_mov_b32 s46, 0x200
    s_mov_b32 s47, 0x00020000
    s_mov_b32 s48, s22
    s_and_b32 s49, s23, 0xffff
    s_mov_b32 s50, 0x4000
    s_mov_b32 s51, 0x00020000
    s_lshl_b32 s71, s63, 3
    s_add_u32 s71, s71, s54
    s_mul_i32 s71, s71, 6144
    s_lshl_b32 s59, s55, 8
    s_add_u32 s59, s59, s71
    v_mov_b32 v4, 0
    v_lshlrev_b32 v5, 7, v1
    s_mov_b64 exec, 3
    buffer_store_dword v4, v5, s[40:43], s59 offen sc1
    s_mov_b64 exec, -1
    v_and_b32 v150, 7, v1
    v_lshlrev_b32 v150, 7, v150
    v_add_u32 v150, s71, v150
    v_mul_u32_u24 v151, 12, v1
    s_mul_i32 s59, s55, 1536
    v_add_u32 v151, s59, v151
    v_mov_b32 v152, 1
    v_lshrrev_b32 v10, 4, v1
    v_and_b32 v11, 7, v1
    v_xor_b32 v10, v10, v11
    v_lshlrev_b32 v10, 4, v10
    v_xor_b32 v11, 64, v10
    s_waitcnt vmcnt(5)
    v_lshrrev_b32 v4, 3, v1
    v_lshlrev_b32 v4, 7, v4
    v_add_u32 v4, s56, v4
    v_add_u32 v4, 0x24000, v4
    ds_read_b32 v36, v4 offset:96
    ds_read_b32 v64, v4 offset:1120
    ds_read_b32 v92, v4 offset:2144
    ds_read_b32 v120, v4 offset:3168
    s_lshr_b32 s59, s100, 13
    s_add_u32 s59, s59, 0
    s_sub_u32 s101, s59, 96
    s_cselect_b32 s59, s59, s101
    v_add_u32 v5, s59, v4
    ds_read_b128 v[12:15], v5 offset:0
    ds_read_b128 v[40:43], v5 offset:1024
    ds_read_b128 v[68:71], v5 offset:2048
    ds_read_b128 v[96:99], v5 offset:3072
    s_waitcnt lgkmcnt(0)
    v_lshl_or_b32 v36, v36, 7, v10
    v_lshl_or_b32 v64, v64, 7, v11
    v_lshl_or_b32 v92, v92, 7, v10
    v_lshl_or_b32 v120, v120, 7, v11
    v_lshl_or_b32 v12, v12, 7, v10
    v_lshl_or_b32 v40, v40, 7, v11
    v_lshl_or_b32 v68, v68, 7, v10
    v_lshl_or_b32 v96, v96, 7, v11
    v_lshl_or_b32 v13, v13, 7, v10
    v_lshl_or_b32 v41, v41, 7, v11
    v_lshl_or_b32 v69, v69, 7, v10
    v_lshl_or_b32 v97, v97, 7, v11
    v_lshl_or_b32 v14, v14, 7, v10
    v_lshl_or_b32 v42, v42, 7, v11
    v_lshl_or_b32 v70, v70, 7, v10
    v_lshl_or_b32 v98, v98, 7, v11
    v_lshl_or_b32 v15, v15, 7, v10
    v_lshl_or_b32 v43, v43, 7, v11
    v_lshl_or_b32 v71, v71, 7, v10
    v_lshl_or_b32 v99, v99, 7, v11
    s_add_u32 m0, s56, 0x10000
    s_nop 0
    buffer_load_dwordx4 v36, s[28:31], 0 offen lds
    s_add_u32 m0, s56, 0x10400
    s_nop 0
    buffer_load_dwordx4 v64, s[28:31], 0 offen lds
    s_add_u32 m0, s56, 0x10800
    s_nop 0
    buffer_load_dwordx4 v92, s[28:31], 0 offen lds
    s_add_u32 m0, s56, 0x10c00
    s_nop 0
    buffer_load_dwordx4 v120, s[28:31], 0 offen lds
    s_lshr_b32 s59, s100, 13
    s_add_u32 s59, s59, 16
    s_sub_u32 s101, s59, 96
    s_cselect_b32 s59, s59, s101
    v_add_u32 v5, s59, v4
    ds_read_b128 v[16:19], v5 offset:0
    ds_read_b128 v[44:47], v5 offset:1024
    ds_read_b128 v[72:75], v5 offset:2048
    ds_read_b128 v[100:103], v5 offset:3072
    s_lshr_b32 s59, s100, 13
    s_add_u32 s59, s59, 32
    s_sub_u32 s101, s59, 96
    s_cselect_b32 s59, s59, s101
    v_add_u32 v5, s59, v4
    ds_read_b128 v[20:23], v5 offset:0
    ds_read_b128 v[48:51], v5 offset:1024
    ds_read_b128 v[76:79], v5 offset:2048
    ds_read_b128 v[104:107], v5 offset:3072
    s_lshr_b32 s59, s100, 13
    s_add_u32 s59, s59, 48
    s_sub_u32 s101, s59, 96
    s_cselect_b32 s59, s59, s101
    v_add_u32 v5, s59, v4
    ds_read_b128 v[24:27], v5 offset:0
    ds_read_b128 v[52:55], v5 offset:1024
    ds_read_b128 v[80:83], v5 offset:2048
    ds_read_b128 v[108:111], v5 offset:3072
    s_lshr_b32 s59, s100, 13
    s_add_u32 s59, s59, 64
    s_sub_u32 s101, s59, 96
    s_cselect_b32 s59, s59, s101
    v_add_u32 v5, s59, v4
    ds_read_b128 v[28:31], v5 offset:0
    ds_read_b128 v[56:59], v5 offset:1024
    ds_read_b128 v[84:87], v5 offset:2048
    ds_read_b128 v[112:115], v5 offset:3072
    s_lshr_b32 s59, s100, 13
    s_add_u32 s59, s59, 80
    s_sub_u32 s101, s59, 96
    s_cselect_b32 s59, s59, s101
    v_add_u32 v5, s59, v4
    ds_read_b128 v[32:35], v5 offset:0
    ds_read_b128 v[60:63], v5 offset:1024
    ds_read_b128 v[88:91], v5 offset:2048
    ds_read_b128 v[116:119], v5 offset:3072
    s_waitcnt lgkmcnt(0)
    v_lshl_or_b32 v16, v16, 7, v10
    v_lshl_or_b32 v44, v44, 7, v11
    v_lshl_or_b32 v72, v72, 7, v10
    v_lshl_or_b32 v100, v100, 7, v11
    v_lshl_or_b32 v17, v17, 7, v10
    v_lshl_or_b32 v45, v45, 7, v11
    v_lshl_or_b32 v73, v73, 7, v10
    v_lshl_or_b32 v101, v101, 7, v11
    v_lshl_or_b32 v18, v18, 7, v10
    v_lshl_or_b32 v46, v46, 7, v11
    v_lshl_or_b32 v74, v74, 7, v10
    v_lshl_or_b32 v102, v102, 7, v11
    v_lshl_or_b32 v19, v19, 7, v10
    v_lshl_or_b32 v47, v47, 7, v11
    v_lshl_or_b32 v75, v75, 7, v10
    v_lshl_or_b32 v103, v103, 7, v11
    v_lshl_or_b32 v20, v20, 7, v10
    v_lshl_or_b32 v48, v48, 7, v11
    v_lshl_or_b32 v76, v76, 7, v10
    v_lshl_or_b32 v104, v104, 7, v11
    v_lshl_or_b32 v21, v21, 7, v10
    v_lshl_or_b32 v49, v49, 7, v11
    v_lshl_or_b32 v77, v77, 7, v10
    v_lshl_or_b32 v105, v105, 7, v11
    v_lshl_or_b32 v22, v22, 7, v10
    v_lshl_or_b32 v50, v50, 7, v11
    v_lshl_or_b32 v78, v78, 7, v10
    v_lshl_or_b32 v106, v106, 7, v11
    v_lshl_or_b32 v23, v23, 7, v10
    v_lshl_or_b32 v51, v51, 7, v11
    v_lshl_or_b32 v79, v79, 7, v10
    v_lshl_or_b32 v107, v107, 7, v11
    v_lshl_or_b32 v24, v24, 7, v10
    v_lshl_or_b32 v52, v52, 7, v11
    v_lshl_or_b32 v80, v80, 7, v10
    v_lshl_or_b32 v108, v108, 7, v11
    v_lshl_or_b32 v25, v25, 7, v10
    v_lshl_or_b32 v53, v53, 7, v11
    v_lshl_or_b32 v81, v81, 7, v10
    v_lshl_or_b32 v109, v109, 7, v11
    v_lshl_or_b32 v26, v26, 7, v10
    v_lshl_or_b32 v54, v54, 7, v11
    v_lshl_or_b32 v82, v82, 7, v10
    v_lshl_or_b32 v110, v110, 7, v11
    v_lshl_or_b32 v27, v27, 7, v10
    v_lshl_or_b32 v55, v55, 7, v11
    v_lshl_or_b32 v83, v83, 7, v10
    v_lshl_or_b32 v111, v111, 7, v11
    v_lshl_or_b32 v28, v28, 7, v10
    v_lshl_or_b32 v56, v56, 7, v11
    v_lshl_or_b32 v84, v84, 7, v10
    v_lshl_or_b32 v112, v112, 7, v11
    v_lshl_or_b32 v29, v29, 7, v10
    v_lshl_or_b32 v57, v57, 7, v11
    v_lshl_or_b32 v85, v85, 7, v10
    v_lshl_or_b32 v113, v113, 7, v11
    v_lshl_or_b32 v30, v30, 7, v10
    v_lshl_or_b32 v58, v58, 7, v11
    v_lshl_or_b32 v86, v86, 7, v10
    v_lshl_or_b32 v114, v114, 7, v11
    v_lshl_or_b32 v31, v31, 7, v10
    v_lshl_or_b32 v59, v59, 7, v11
    v_lshl_or_b32 v87, v87, 7, v10
    v_lshl_or_b32 v115, v115, 7, v11
    v_lshl_or_b32 v32, v32, 7, v10
    v_lshl_or_b32 v60, v60, 7, v11
    v_lshl_or_b32 v88, v88, 7, v10
    v_lshl_or_b32 v116, v116, 7, v11
    v_lshl_or_b32 v33, v33, 7, v10
    v_lshl_or_b32 v61, v61, 7, v11
    v_lshl_or_b32 v89, v89, 7, v10
    v_lshl_or_b32 v117, v117, 7, v11
    v_lshl_or_b32 v34, v34, 7, v10
    v_lshl_or_b32 v62, v62, 7, v11
    v_lshl_or_b32 v90, v90, 7, v10
    v_lshl_or_b32 v118, v118, 7, v11
    v_lshl_or_b32 v35, v35, 7, v10
    v_lshl_or_b32 v63, v63, 7, v11
    v_lshl_or_b32 v91, v91, 7, v10
    v_lshl_or_b32 v119, v119, 7, v11
    s_and_b32 s59, s53, 1
    s_lshl_b32 s59, s59, 1
    s_or_b32 s59, s59, s68
    s_cmp_eq_u32 s59, 1
    s_cbranch_scc1 L_var1
    s_cmp_eq_u32 s59, 2
    s_cbranch_scc1 L_var2
    s_cmp_eq_u32 s59, 3
    s_cbranch_scc1 L_var3
L_var0:
    s_add_u32 m0, s56, 0x14000
    s_nop 0
    buffer_load_dwordx4 v12, s[28:31], 0 offen lds
    s_add_u32 m0, s56, 0x14400
    s_nop 0
    buffer_load_dwordx4 v40, s[28:31], 0 offen lds
    s_add_u32 m0, s56, 0x14800
    s_nop 0
    buffer_load_dwordx4 v68, s[28:31], 0 offen lds
    s_add_u32 m0, s56, 0x14c00
    s_nop 0
    buffer_load_dwordx4 v96, s[28:31], 0 offen lds
    s_add_u32 m0, s56, 0x18000
    s_nop 0
    buffer_load_dwordx4 v13, s[28:31], 0 offen lds
    s_add_u32 m0, s56, 0x18400
    s_nop 0
    buffer_load_dwordx4 v41, s[28:31], 0 offen lds
    s_add_u32 m0, s56, 0x18800
    s_nop 0
    buffer_load_dwordx4 v69, s[28:31], 0 offen lds
    s_add_u32 m0, s56, 0x18c00
    s_nop 0
    buffer_load_dwordx4 v97, s[28:31], 0 offen lds
    s_waitcnt vmcnt(8)
    s_barrier
    s_add_u32 s62, s100, 0x0
    s_sub_u32 s101, s62, 0xc0000
    s_cselect_b32 s62, s62, s101
    s_add_u32 s62, s62, s94
    s_add_u32 m0, s56, 0x4000
    s_nop 0
    buffer_load_dwordx4 v6, s[32:35], s62 offen lds
    s_add_u32 m0, s56, 0x4400
    s_nop 0
    buffer_load_dwordx4 v7, s[32:35], s62 offen lds
    s_add_u32 m0, s56, 0x4800
    s_nop 0
    buffer_load_dwordx4 v8, s[32:35], s62 offen lds
    s_add_u32 m0, s56, 0x4c00
    s_nop 0
    buffer_load_dwordx4 v9, s[32:35], s62 offen lds
    s_add_u32 s62, s100, 0x0
    s_sub_u32 s101, s62, 0xc0000
    s_cselect_b32 s62, s62, s101
    s_add_u32 s62, s62, s94
    s_add_u32 s62, s62, 0x8000
    s_add_u32 m0, s56, 0x8000
    s_nop 0
    buffer_load_dwordx4 v6, s[32:35], s62 offen lds
    s_add_u32 m0, s56, 0x8400
    s_nop 0
    buffer_load_dwordx4 v7, s[32:35], s62 offen lds
    s_add_u32 m0, s56, 0x8800
    s_nop 0
    buffer_load_dwordx4 v8, s[32:35], s62 offen lds
    s_add_u32 m0, s56, 0x8c00
    s_nop 0
    buffer_load_dwordx4 v9, s[32:35], s62 offen lds
    s_add_u32 m0, s56, 0x1c000
    s_nop 0
    buffer_load_dwordx4 v14, s[28:31], 0 offen lds
    s_add_u32 m0, s56, 0x1c400
    s_nop 0
    buffer_load_dwordx4 v42, s[28:31], 0 offen lds
    s_add_u32 m0, s56, 0x1c800
    s_nop 0
    buffer_load_dwordx4 v70, s[28:31], 0 offen lds
    s_add_u32 m0, s56, 0x1cc00
    s_nop 0
    buffer_load_dwordx4 v98, s[28:31], 0 offen lds
    s_waitcnt vmcnt(8)
    s_barrier
    s_add_u32 m0, s56, 0x20000
    s_nop 0
    buffer_load_dwordx4 v15, s[28:31], 0 offen lds
    s_add_u32 m0, s56, 0x20400
    s_nop 0
    buffer_load_dwordx4 v43, s[28:31], 0 offen lds
    s_add_u32 m0, s56, 0x20800
    s_nop 0
    buffer_load_dwordx4 v71, s[28:31], 0 offen lds
    s_add_u32 m0, s56, 0x20c00
    s_nop 0
    buffer_load_dwordx4 v99, s[28:31], 0 offen lds
    s_add_u32 s62, s100, 0x0
    s_sub_u32 s101, s62, 0xc0000
    s_cselect_b32 s62, s62, s101
    s_add_u32 s62, s62, s94
    s_add_u32 s62, s62, 0x10000
    s_add_u32 m0, s56, 0xc000
    s_nop 0
    buffer_load_dwordx4 v6, s[32:35], s62 offen lds
    s_add_u32 m0, s56, 0xc400
    s_nop 0
    buffer_load_dwordx4 v7, s[32:35], s62 offen lds
    s_add_u32 m0, s56, 0xc800
    s_nop 0
    buffer_load_dwordx4 v8, s[32:35], s62 offen lds
    s_add_u32 m0, s56, 0xcc00
    s_nop 0
    buffer_load_dwordx4 v9, s[32:35], s62 offen lds
    s_add_u32 s62, s100, 0x0
    s_sub_u32 s101, s62, 0xc0000
    s_cselect_b32 s62, s62, s101
    s_add_u32 s62, s62, s94
    s_add_u32 s62, s62, 0x18000
    s_add_u32 m0, s56, 0x0
    s_nop 0
    buffer_load_dwordx4 v6, s[32:35], s62 offen lds
    s_add_u32 m0, s56, 0x400
    s_nop 0
    buffer_load_dwordx4 v7, s[32:35], s62 offen lds
    s_add_u32 m0, s56, 0x800
    s_nop 0
    buffer_load_dwordx4 v8, s[32:35], s62 offen lds
    s_add_u32 m0, s56, 0xc00
    s_nop 0
    buffer_load_dwordx4 v9, s[32:35], s62 offen lds
    s_waitcnt vmcnt(16)
    s_barrier
    s_add_u32 m0, s56, 0x24000
    s_nop 0
    buffer_load_dwordx4 v16, s[28:31], 0 offen lds
    s_add_u32 m0, s56, 0x24400
    s_nop 0
    buffer_load_dwordx4 v44, s[28:31], 0 offen lds
    s_add_u32 m0, s56, 0x24800
    s_nop 0
    buffer_load_dwordx4 v72, s[28:31], 0 offen lds
    s_add_u32 m0, s56, 0x24c00
    s_nop 0
    buffer_load_dwordx4 v100, s[28:31], 0 offen lds
    s_add_u32 m0, s56, 0x10000
    s_nop 0
    buffer_load_dwordx4 v17, s[28:31], 0 offen lds
    s_add_u32 m0, s56, 0x10400
    s_nop 0
    buffer_load_dwordx4 v45, s[28:31], 0 offen lds
    s_add_u32 m0, s56, 0x10800
    s_nop 0
    buffer_load_dwordx4 v73, s[28:31], 0 offen lds
    s_add_u32 m0, s56, 0x10c00
    s_nop 0
    buffer_load_dwordx4 v101, s[28:31], 0 offen lds
    s_add_u32 s62, s100, 0x20000
    s_sub_u32 s101, s62, 0xc0000
    s_cselect_b32 s62, s62, s101
    s_add_u32 s62, s62, s94
    s_add_u32 m0, s56, 0x4000
    s_nop 0
    buffer_load_dwordx4 v6, s[32:35], s62 offen lds
    s_add_u32 m0, s56, 0x4400
    s_nop 0
    buffer_load_dwordx4 v7, s[32:35], s62 offen lds
    s_add_u32 m0, s56, 0x4800
    s_nop 0
    buffer_load_dwordx4 v8, s[32:35], s62 offen lds
    s_add_u32 m0, s56, 0x4c00
    s_nop 0
    buffer_load_dwordx4 v9, s[32:35], s62 offen lds
    s_waitcnt vmcnt(16)
    s_barrier
    s_add_u32 s62, s100, 0x20000
    s_sub_u32 s101, s62, 0xc0000
    s_cselect_b32 s62, s62, s101
    s_add_u32 s62, s62, s94
    s_add_u32 s62, s62, 0x8000
    s_add_u32 m0, s56, 0x8000
    s_nop 0
    buffer_load_dwordx4 v6, s[32:35], s62 offen lds
    s_add_u32 m0, s56, 0x8400
    s_nop 0
    buffer_load_dwordx4 v7, s[32:35], s62 offen lds
    s_add_u32 m0, s56, 0x8800
    s_nop 0
    buffer_load_dwordx4 v8, s[32:35], s62 offen lds
    s_add_u32 m0, s56, 0x8c00
    s_nop 0
    buffer_load_dwordx4 v9, s[32:35], s62 offen lds
    s_add_u32 m0, s56, 0x14000
    s_nop 0
    buffer_load_dwordx4 v18, s[28:31], 0 offen lds
    s_add_u32 m0, s56, 0x14400
    s_nop 0
    buffer_load_dwordx4 v46, s[28:31], 0 offen lds
    s_add_u32 m0, s56, 0x14800
    s_nop 0
    buffer_load_dwordx4 v74, s[28:31], 0 offen lds
    s_add_u32 m0, s56, 0x14c00
    s_nop 0
    buffer_load_dwordx4 v102, s[28:31], 0 offen lds
    s_add_u32 m0, s56, 0x18000
    s_nop 0
    buffer_load_dwordx4 v19, s[28:31], 0 offen lds
    s_add_u32 m0, s56, 0x18400
    s_nop 0
    buffer_load_dwordx4 v47, s[28:31], 0 offen lds
    s_add_u32 m0, s56, 0x18800
    s_nop 0
    buffer_load_dwordx4 v75, s[28:31], 0 offen lds
    s_add_u32 m0, s56, 0x18c00
    s_nop 0
    buffer_load_dwordx4 v103, s[28:31], 0 offen lds
    s_cmp_lg_u32 s55, 0
    s_cbranch_scc1 L_nordy0
    v_mov_b32 v2, s63
    s_mov_b64 exec, 1
    buffer_store_byte v152, v2, s[44:47], 0 offen sc1
    s_mov_b64 exec, -1
L_nordy0:
    s_waitcnt vmcnt(24)
    s_barrier
    s_add_u32 s62, s100, 0x20000
    s_sub_u32 s101, s62, 0xc0000
    s_cselect_b32 s62, s62, s101
    s_add_u32 s62, s62, s94
    s_add_u32 s62, s62, 0x10000
    s_add_u32 m0, s56, 0xc000
    s_nop 0
    buffer_load_dwordx4 v6, s[32:35], s62 offen lds
    s_add_u32 m0, s56, 0xc400
    s_nop 0
    buffer_load_dwordx4 v7, s[32:35], s62 offen lds
    s_add_u32 m0, s56, 0xc800
    s_nop 0
    buffer_load_dwordx4 v8, s[32:35], s62 offen lds
    s_add_u32 m0, s56, 0xcc00
    s_nop 0
    buffer_load_dwordx4 v9, s[32:35], s62 offen lds
    s_waitcnt vmcnt(16)
    s_barrier
    s_add_u32 s62, s100, 0x20000
    s_sub_u32 s101, s62, 0xc0000
    s_cselect_b32 s62, s62, s101
    s_add_u32 s62, s62, s94
    s_add_u32 s62, s62, 0x18000
    s_add_u32 m0, s56, 0x0
    s_nop 0
    buffer_load_dwordx4 v6, s[32:35], s62 offen lds
    s_add_u32 m0, s56, 0x400
    s_nop 0
    buffer_load_dwordx4 v7, s[32:35], s62 offen lds
    s_add_u32 m0, s56, 0x800
    s_nop 0
    buffer_load_dwordx4 v8, s[32:35], s62 offen lds
    s_add_u32 m0, s56, 0xc00
    s_nop 0
    buffer_load_dwordx4 v9, s[32:35], s62 offen lds
    s_add_u32 m0, s56, 0x1c000
    s_nop 0
    buffer_load_dwordx4 v20, s[28:31], 0 offen lds
    s_add_u32 m0, s56, 0x1c400
    s_nop 0
    buffer_load_dwordx4 v48, s[28:31], 0 offen lds
    s_add_u32 m0, s56, 0x1c800
    s_nop 0
    buffer_load_dwordx4 v76, s[28:31], 0 offen lds
    s_add_u32 m0, s56, 0x1cc00
    s_nop 0
    buffer_load_dwordx4 v104, s[28:31], 0 offen lds
    s_waitcnt vmcnt(20)
    s_barrier
    s_add_u32 m0, s56, 0x20000
    s_nop 0
    buffer_load_dwordx4 v21, s[28:31], 0 offen lds
    s_add_u32 m0, s56, 0x20400
    s_nop 0
    buffer_load_dwordx4 v49, s[28:31], 0 offen lds
    s_add_u32 m0, s56, 0x20800
    s_nop 0
    buffer_load_dwordx4 v77, s[28:31], 0 offen lds
    s_add_u32 m0, s56, 0x20c00
    s_nop 0
    buffer_load_dwordx4 v105, s[28:31], 0 offen lds
    s_add_u32 s62, s100, 0x40000
    s_sub_u32 s101, s62, 0xc0000
    s_cselect_b32 s62, s62, s101
    s_add_u32 s62, s62, s94
    s_add_u32 m0, s56, 0x4000
    s_nop 0
    buffer_load_dwordx4 v6, s[32:35], s62 offen lds
    s_add_u32 m0, s56, 0x4400
    s_nop 0
    buffer_load_dwordx4 v7, s[32:35], s62 offen lds
    s_add_u32 m0, s56, 0x4800
    s_nop 0
    buffer_load_dwordx4 v8, s[32:35], s62 offen lds
    s_add_u32 m0, s56, 0x4c00
    s_nop 0
    buffer_load_dwordx4 v9, s[32:35], s62 offen lds
    s_waitcnt vmcnt(16)
    s_barrier
    s_add_u32 s62, s100, 0x40000
    s_sub_u32 s101, s62, 0xc0000
    s_cselect_b32 s62, s62, s101
    s_add_u32 s62, s62, s94
    s_add_u32 s62, s62, 0x8000
    s_add_u32 m0, s56, 0x8000
    s_nop 0
    buffer_load_dwordx4 v6, s[32:35], s62 offen lds
    s_add_u32 m0, s56, 0x8400
    s_nop 0
    buffer_load_dwordx4 v7, s[32:35], s62 offen lds
    s_add_u32 m0, s56, 0x8800
    s_nop 0
    buffer_load_dwordx4 v8, s[32:35], s62 offen lds
    s_add_u32 m0, s56, 0x8c00
    s_nop 0
    buffer_load_dwordx4 v9, s[32:35], s62 offen lds
    s_add_u32 m0, s56, 0x24000
    s_nop 0
    buffer_load_dwordx4 v22, s[28:31], 0 offen lds
    s_add_u32 m0, s56, 0x24400
    s_nop 0
    buffer_load_dwordx4 v50, s[28:31], 0 offen lds
    s_add_u32 m0, s56, 0x24800
    s_nop 0
    buffer_load_dwordx4 v78, s[28:31], 0 offen lds
    s_add_u32 m0, s56, 0x24c00
    s_nop 0
    buffer_load_dwordx4 v106, s[28:31], 0 offen lds
    s_waitcnt vmcnt(20)
    s_barrier
    s_add_u32 m0, s56, 0x10000
    s_nop 0
    buffer_load_dwordx4 v23, s[28:31], 0 offen lds
    s_add_u32 m0, s56, 0x10400
    s_nop 0
    buffer_load_dwordx4 v51, s[28:31], 0 offen lds
    s_add_u32 m0, s56, 0x10800
    s_nop 0
    buffer_load_dwordx4 v79, s[28:31], 0 offen lds
    s_add_u32 m0, s56, 0x10c00
    s_nop 0
    buffer_load_dwordx4 v107, s[28:31], 0 offen lds
    s_add_u32 s62, s100, 0x40000
    s_sub_u32 s101, s62, 0xc0000
    s_cselect_b32 s62, s62, s101
    s_add_u32 s62, s62, s94
    s_add_u32 s62, s62, 0x10000
    s_add_u32 m0, s56, 0xc000
    s_nop 0
    buffer_load_dwordx4 v6, s[32:35], s62 offen lds
    s_add_u32 m0, s56, 0xc400
    s_nop 0
    buffer_load_dwordx4 v7, s[32:35], s62 offen lds
    s_add_u32 m0, s56, 0xc800
    s_nop 0
    buffer_load_dwordx4 v8, s[32:35], s62 offen lds
    s_add_u32 m0, s56, 0xcc00
    s_nop 0
    buffer_load_dwordx4 v9, s[32:35], s62 offen lds
    s_waitcnt vmcnt(16)
    s_barrier
    s_add_u32 s62, s100, 0x40000
    s_sub_u32 s101, s62, 0xc0000
    s_cselect_b32 s62, s62, s101
    s_add_u32 s62, s62, s94
    s_add_u32 s62, s62, 0x18000
    s_add_u32 m0, s56, 0x0
    s_nop 0
    buffer_load_dwordx4 v6, s[32:35], s62 offen lds
    s_add_u32 m0, s56, 0x400
    s_nop 0
    buffer_load_dwordx4 v7, s[32:35], s62 offen lds
    s_add_u32 m0, s56, 0x800
    s_nop 0
    buffer_load_dwordx4 v8, s[32:35], s62 offen lds
    s_add_u32 m0, s56, 0xc00
    s_nop 0
    buffer_load_dwordx4 v9, s[32:35], s62 offen lds
    s_add_u32 m0, s56, 0x14000
    s_nop 0
    buffer_load_dwordx4 v24, s[28:31], 0 offen lds
    s_add_u32 m0, s56, 0x14400
    s_nop 0
    buffer_load_dwordx4 v52, s[28:31], 0 offen lds
    s_add_u32 m0, s56, 0x14800
    s_nop 0
    buffer_load_dwordx4 v80, s[28:31], 0 offen lds
    s_add_u32 m0, s56, 0x14c00
    s_nop 0
    buffer_load_dwordx4 v108, s[28:31], 0 offen lds
    s_waitcnt vmcnt(20)
    s_barrier
    s_add_u32 m0, s56, 0x18000
    s_nop 0
    buffer_load_dwordx4 v25, s[28:31], 0 offen lds
    s_add_u32 m0, s56, 0x18400
    s_nop 0
    buffer_load_dwordx4 v53, s[28:31], 0 offen lds
    s_add_u32 m0, s56, 0x18800
    s_nop 0
    buffer_load_dwordx4 v81, s[28:31], 0 offen lds
    s_add_u32 m0, s56, 0x18c00
    s_nop 0
    buffer_load_dwordx4 v109, s[28:31], 0 offen lds
    s_add_u32 s62, s100, 0x60000
    s_sub_u32 s101, s62, 0xc0000
    s_cselect_b32 s62, s62, s101
    s_add_u32 s62, s62, s94
    s_add_u32 m0, s56, 0x4000
    s_nop 0
    buffer_load_dwordx4 v6, s[32:35], s62 offen lds
    s_add_u32 m0, s56, 0x4400
    s_nop 0
    buffer_load_dwordx4 v7, s[32:35], s62 offen lds
    s_add_u32 m0, s56, 0x4800
    s_nop 0
    buffer_load_dwordx4 v8, s[32:35], s62 offen lds
    s_add_u32 m0, s56, 0x4c00
    s_nop 0
    buffer_load_dwordx4 v9, s[32:35], s62 offen lds
    s_waitcnt vmcnt(16)
    s_barrier
    s_add_u32 s62, s100, 0x60000
    s_sub_u32 s101, s62, 0xc0000
    s_cselect_b32 s62, s62, s101
    s_add_u32 s62, s62, s94
    s_add_u32 s62, s62, 0x8000
    s_add_u32 m0, s56, 0x8000
    s_nop 0
    buffer_load_dwordx4 v6, s[32:35], s62 offen lds
    s_add_u32 m0, s56, 0x8400
    s_nop 0
    buffer_load_dwordx4 v7, s[32:35], s62 offen lds
    s_add_u32 m0, s56, 0x8800
    s_nop 0
    buffer_load_dwordx4 v8, s[32:35], s62 offen lds
    s_add_u32 m0, s56, 0x8c00
    s_nop 0
    buffer_load_dwordx4 v9, s[32:35], s62 offen lds
    s_add_u32 m0, s56, 0x1c000
    s_nop 0
    buffer_load_dwordx4 v26, s[28:31], 0 offen lds
    s_add_u32 m0, s56, 0x1c400
    s_nop 0
    buffer_load_dwordx4 v54, s[28:31], 0 offen lds
    s_add_u32 m0, s56, 0x1c800
    s_nop 0
    buffer_load_dwordx4 v82, s[28:31], 0 offen lds
    s_add_u32 m0, s56, 0x1cc00
    s_nop 0
    buffer_load_dwordx4 v110, s[28:31], 0 offen lds
    s_waitcnt vmcnt(20)
    s_barrier
    s_add_u32 m0, s56, 0x20000
    s_nop 0
    buffer_load_dwordx4 v27, s[28:31], 0 offen lds
    s_add_u32 m0, s56, 0x20400
    s_nop 0
    buffer_load_dwordx4 v55, s[28:31], 0 offen lds
    s_add_u32 m0, s56, 0x20800
    s_nop 0
    buffer_load_dwordx4 v83, s[28:31], 0 offen lds
    s_add_u32 m0, s56, 0x20c00
    s_nop 0
    buffer_load_dwordx4 v111, s[28:31], 0 offen lds
    s_add_u32 s62, s100, 0x60000
    s_sub_u32 s101, s62, 0xc0000
    s_cselect_b32 s62, s62, s101
    s_add_u32 s62, s62, s94
    s_add_u32 s62, s62, 0x10000
    s_add_u32 m0, s56, 0xc000
    s_nop 0
    buffer_load_dwordx4 v6, s[32:35], s62 offen lds
    s_add_u32 m0, s56, 0xc400
    s_nop 0
    buffer_load_dwordx4 v7, s[32:35], s62 offen lds
    s_add_u32 m0, s56, 0xc800
    s_nop 0
    buffer_load_dwordx4 v8, s[32:35], s62 offen lds
    s_add_u32 m0, s56, 0xcc00
    s_nop 0
    buffer_load_dwordx4 v9, s[32:35], s62 offen lds
    s_waitcnt vmcnt(16)
    s_barrier
    s_add_u32 s62, s100, 0x60000
    s_sub_u32 s101, s62, 0xc0000
    s_cselect_b32 s62, s62, s101
    s_add_u32 s62, s62, s94
    s_add_u32 s62, s62, 0x18000
    s_add_u32 m0, s56, 0x0
    s_nop 0
    buffer_load_dwordx4 v6, s[32:35], s62 offen lds
    s_add_u32 m0, s56, 0x400
    s_nop 0
    buffer_load_dwordx4 v7, s[32:35], s62 offen lds
    s_add_u32 m0, s56, 0x800
    s_nop 0
    buffer_load_dwordx4 v8, s[32:35], s62 offen lds
    s_add_u32 m0, s56, 0xc00
    s_nop 0
    buffer_load_dwordx4 v9, s[32:35], s62 offen lds
    s_add_u32 m0, s56, 0x24000
    s_nop 0
    buffer_load_dwordx4 v28, s[28:31], 0 offen lds
    s_add_u32 m0, s56, 0x24400
    s_nop 0
    buffer_load_dwordx4 v56, s[28:31], 0 offen lds
    s_add_u32 m0, s56, 0x24800
    s_nop 0
    buffer_load_dwordx4 v84, s[28:31], 0 offen lds
    s_add_u32 m0, s56, 0x24c00
    s_nop 0
    buffer_load_dwordx4 v112, s[28:31], 0 offen lds
    s_waitcnt vmcnt(20)
    s_barrier
    s_add_u32 m0, s56, 0x10000
    s_nop 0
    buffer_load_dwordx4 v29, s[28:31], 0 offen lds
    s_add_u32 m0, s56, 0x10400
    s_nop 0
    buffer_load_dwordx4 v57, s[28:31], 0 offen lds
    s_add_u32 m0, s56, 0x10800
    s_nop 0
    buffer_load_dwordx4 v85, s[28:31], 0 offen lds
    s_add_u32 m0, s56, 0x10c00
    s_nop 0
    buffer_load_dwordx4 v113, s[28:31], 0 offen lds
    s_add_u32 s62, s100, 0x80000
    s_sub_u32 s101, s62, 0xc0000
    s_cselect_b32 s62, s62, s101
    s_add_u32 s62, s62, s94
    s_add_u32 m0, s56, 0x4000
    s_nop 0
    buffer_load_dwordx4 v6, s[32:35], s62 offen lds
    s_add_u32 m0, s56, 0x4400
    s_nop 0
    buffer_load_dwordx4 v7, s[32:35], s62 offen lds
    s_add_u32 m0, s56, 0x4800
    s_nop 0
    buffer_load_dwordx4 v8, s[32:35], s62 offen lds
    s_add_u32 m0, s56, 0x4c00
    s_nop 0
    buffer_load_dwordx4 v9, s[32:35], s62 offen lds
    s_waitcnt vmcnt(16)
    s_barrier
    s_add_u32 s62, s100, 0x80000
    s_sub_u32 s101, s62, 0xc0000
    s_cselect_b32 s62, s62, s101
    s_add_u32 s62, s62, s94
    s_add_u32 s62, s62, 0x8000
    s_add_u32 m0, s56, 0x8000
    s_nop 0
    buffer_load_dwordx4 v6, s[32:35], s62 offen lds
    s_add_u32 m0, s56, 0x8400
    s_nop 0
    buffer_load_dwordx4 v7, s[32:35], s62 offen lds
    s_add_u32 m0, s56, 0x8800
    s_nop 0
    buffer_load_dwordx4 v8, s[32:35], s62 offen lds
    s_add_u32 m0, s56, 0x8c00
    s_nop 0
    buffer_load_dwordx4 v9, s[32:35], s62 offen lds
    s_add_u32 m0, s56, 0x14000
    s_nop 0
    buffer_load_dwordx4 v30, s[28:31], 0 offen lds
    s_add_u32 m0, s56, 0x14400
    s_nop 0
    buffer_load_dwordx4 v58, s[28:31], 0 offen lds
    s_add_u32 m0, s56, 0x14800
    s_nop 0
    buffer_load_dwordx4 v86, s[28:31], 0 offen lds
    s_add_u32 m0, s56, 0x14c00
    s_nop 0
    buffer_load_dwordx4 v114, s[28:31], 0 offen lds
    s_waitcnt vmcnt(20)
    s_barrier
    s_add_u32 m0, s56, 0x18000
    s_nop 0
    buffer_load_dwordx4 v31, s[28:31], 0 offen lds
    s_add_u32 m0, s56, 0x18400
    s_nop 0
    buffer_load_dwordx4 v59, s[28:31], 0 offen lds
    s_add_u32 m0, s56, 0x18800
    s_nop 0
    buffer_load_dwordx4 v87, s[28:31], 0 offen lds
    s_add_u32 m0, s56, 0x18c00
    s_nop 0
    buffer_load_dwordx4 v115, s[28:31], 0 offen lds
    s_add_u32 s62, s100, 0x80000
    s_sub_u32 s101, s62, 0xc0000
    s_cselect_b32 s62, s62, s101
    s_add_u32 s62, s62, s94
    s_add_u32 s62, s62, 0x10000
    s_add_u32 m0, s56, 0xc000
    s_nop 0
    buffer_load_dwordx4 v6, s[32:35], s62 offen lds
    s_add_u32 m0, s56, 0xc400
    s_nop 0
    buffer_load_dwordx4 v7, s[32:35], s62 offen lds
    s_add_u32 m0, s56, 0xc800
    s_nop 0
    buffer_load_dwordx4 v8, s[32:35], s62 offen lds
    s_add_u32 m0, s56, 0xcc00
    s_nop 0
    buffer_load_dwordx4 v9, s[32:35], s62 offen lds
    s_waitcnt vmcnt(16)
    s_barrier
    s_add_u32 s62, s100, 0x80000
    s_sub_u32 s101, s62, 0xc0000
    s_cselect_b32 s62, s62, s101
    s_add_u32 s62, s62, s94
    s_add_u32 s62, s62, 0x18000
    s_add_u32 m0, s56, 0x0
    s_nop 0
    buffer_load_dwordx4 v6, s[32:35], s62 offen lds
    s_add_u32 m0, s56, 0x400
    s_nop 0
    buffer_load_dwordx4 v7, s[32:35], s62 offen lds
    s_add_u32 m0, s56, 0x800
    s_nop 0
    buffer_load_dwordx4 v8, s[32:35], s62 offen lds
    s_add_u32 m0, s56, 0xc00
    s_nop 0
    buffer_load_dwordx4 v9, s[32:35], s62 offen lds
    s_add_u32 m0, s56, 0x1c000
    s_nop 0
    buffer_load_dwordx4 v32, s[28:31], 0 offen lds
    s_add_u32 m0, s56, 0x1c400
    s_nop 0
    buffer_load_dwordx4 v60, s[28:31], 0 offen lds
    s_add_u32 m0, s56, 0x1c800
    s_nop 0
    buffer_load_dwordx4 v88, s[28:31], 0 offen lds
    s_add_u32 m0, s56, 0x1cc00
    s_nop 0
    buffer_load_dwordx4 v116, s[28:31], 0 offen lds
    s_waitcnt vmcnt(20)
    s_barrier
    s_add_u32 m0, s56, 0x20000
    s_nop 0
    buffer_load_dwordx4 v33, s[28:31], 0 offen lds
    s_add_u32 m0, s56, 0x20400
    s_nop 0
    buffer_load_dwordx4 v61, s[28:31], 0 offen lds
    s_add_u32 m0, s56, 0x20800
    s_nop 0
    buffer_load_dwordx4 v89, s[28:31], 0 offen lds
    s_add_u32 m0, s56, 0x20c00
    s_nop 0
    buffer_load_dwordx4 v117, s[28:31], 0 offen lds
    s_add_u32 s62, s100, 0xa0000
    s_sub_u32 s101, s62, 0xc0000
    s_cselect_b32 s62, s62, s101
    s_add_u32 s62, s62, s94
    s_add_u32 m0, s56, 0x4000
    s_nop 0
    buffer_load_dwordx4 v6, s[32:35], s62 offen lds
    s_add_u32 m0, s56, 0x4400
    s_nop 0
    buffer_load_dwordx4 v7, s[32:35], s62 offen lds
    s_add_u32 m0, s56, 0x4800
    s_nop 0
    buffer_load_dwordx4 v8, s[32:35], s62 offen lds
    s_add_u32 m0, s56, 0x4c00
    s_nop 0
    buffer_load_dwordx4 v9, s[32:35], s62 offen lds
    s_waitcnt vmcnt(16)
    s_barrier
    s_add_u32 s62, s100, 0xa0000
    s_sub_u32 s101, s62, 0xc0000
    s_cselect_b32 s62, s62, s101
    s_add_u32 s62, s62, s94
    s_add_u32 s62, s62, 0x8000
    s_add_u32 m0, s56, 0x8000
    s_nop 0
    buffer_load_dwordx4 v6, s[32:35], s62 offen lds
    s_add_u32 m0, s56, 0x8400
    s_nop 0
    buffer_load_dwordx4 v7, s[32:35], s62 offen lds
    s_add_u32 m0, s56, 0x8800
    s_nop 0
    buffer_load_dwordx4 v8, s[32:35], s62 offen lds
    s_add_u32 m0, s56, 0x8c00
    s_nop 0
    buffer_load_dwordx4 v9, s[32:35], s62 offen lds
    s_add_u32 m0, s56, 0x24000
    s_nop 0
    buffer_load_dwordx4 v34, s[28:31], 0 offen lds
    s_add_u32 m0, s56, 0x24400
    s_nop 0
    buffer_load_dwordx4 v62, s[28:31], 0 offen lds
    s_add_u32 m0, s56, 0x24800
    s_nop 0
    buffer_load_dwordx4 v90, s[28:31], 0 offen lds
    s_add_u32 m0, s56, 0x24c00
    s_nop 0
    buffer_load_dwordx4 v118, s[28:31], 0 offen lds
    s_waitcnt vmcnt(20)
    s_barrier
    s_add_u32 m0, s56, 0x10000
    s_nop 0
    buffer_load_dwordx4 v35, s[28:31], 0 offen lds
    s_add_u32 m0, s56, 0x10400
    s_nop 0
    buffer_load_dwordx4 v63, s[28:31], 0 offen lds
    s_add_u32 m0, s56, 0x10800
    s_nop 0
    buffer_load_dwordx4 v91, s[28:31], 0 offen lds
    s_add_u32 m0, s56, 0x10c00
    s_nop 0
    buffer_load_dwordx4 v119, s[28:31], 0 offen lds
    s_add_u32 s62, s100, 0xa0000
    s_sub_u32 s101, s62, 0xc0000
    s_cselect_b32 s62, s62, s101
    s_add_u32 s62, s62, s94
    s_add_u32 s62, s62, 0x10000
    s_add_u32 m0, s56, 0xc000
    s_nop 0
    buffer_load_dwordx4 v6, s[32:35], s62 offen lds
    s_add_u32 m0, s56, 0xc400
    s_nop 0
    buffer_load_dwordx4 v7, s[32:35], s62 offen lds
    s_add_u32 m0, s56, 0xc800
    s_nop 0
    buffer_load_dwordx4 v8, s[32:35], s62 offen lds
    s_add_u32 m0, s56, 0xcc00
    s_nop 0
    buffer_load_dwordx4 v9, s[32:35], s62 offen lds
    s_waitcnt vmcnt(16)
    s_barrier
    s_add_u32 s62, s100, 0xa0000
    s_sub_u32 s101, s62, 0xc0000
    s_cselect_b32 s62, s62, s101
    s_add_u32 s62, s62, s94
    s_add_u32 s62, s62, 0x18000
    s_add_u32 m0, s56, 0x0
    s_nop 0
    buffer_load_dwordx4 v6, s[32:35], s62 offen lds
    s_add_u32 m0, s56, 0x400
    s_nop 0
    buffer_load_dwordx4 v7, s[32:35], s62 offen lds
    s_add_u32 m0, s56, 0x800
    s_nop 0
    buffer_load_dwordx4 v8, s[32:35], s62 offen lds
    s_add_u32 m0, s56, 0xc00
    s_nop 0
    buffer_load_dwordx4 v9, s[32:35], s62 offen lds
    s_waitcnt vmcnt(16)
    s_barrier
    s_mov_b32 s36, s16
    s_and_b32 s37, s17, 0xffff
    s_mov_b32 s38, 0x200
    s_mov_b32 s39, 0x00020000
    s_mov_b32 s96, s18
    s_and_b32 s97, s19, 0xffff
    s_mov_b32 s98, 0x200
    s_mov_b32 s99, 0x00020000
    s_lshl_b32 s59, s55, 6
    v_lshrrev_b32 v2, 4, v1
    v_lshlrev_b32 v2, 3, v2
    buffer_load_dwordx2 v[124:125], v2, s[36:39], s59 offen offset:0
    buffer_load_dwordx2 v[132:133], v2, s[96:99], s59 offen offset:0
    buffer_load_dwordx2 v[126:127], v2, s[36:39], s59 offen offset:32
    buffer_load_dwordx2 v[134:135], v2, s[96:99], s59 offen offset:32
    buffer_load_dwordx2 v[128:129], v2, s[36:39], s59 offen offset:256
    buffer_load_dwordx2 v[136:137], v2, s[96:99], s59 offen offset:256
    buffer_load_dwordx2 v[130:131], v2, s[36:39], s59 offen offset:288
    buffer_load_dwordx2 v[138:139], v2, s[96:99], s59 offen offset:288
    s_nop 0
    s_mov_b32 s36, s8
    s_and_b32 s37, s9, 0xffff
    s_mov_b32 s38, 0x1a040
    s_mov_b32 s39, 0x00020000
    s_mov_b32 s96, s10
    s_and_b32 s97, s11, 0xffff
    s_mov_b32 s98, 0x40
    s_mov_b32 s99, 0x00020000
    v_and_b32 v3, 15, v1
    s_lshl_b32 s59, s63, 4
    v_add_u32 v3, s59, v3
    v_mul_u32_u24 v3, 26, v3
    v_lshrrev_b32 v2, 2, v2
    v_add_u32 v3, v3, v2
    buffer_load_ushort v140, v3, s[36:39], 0 offen offset:0
    buffer_load_ushort v144, v2, s[96:99], 0 offen offset:0
    buffer_load_ushort v141, v3, s[36:39], 0 offen offset:8
    buffer_load_ushort v145, v2, s[96:99], 0 offen offset:8
    buffer_load_ushort v142, v3, s[36:39], 0 offen offset:16
    buffer_load_ushort v146, v2, s[96:99], 0 offen offset:16
    v_mov_b32 v143, 0
    v_mov_b32 v147, 0
    s_mov_b64 exec, 0xffff
    buffer_load_ushort v143, v3, s[36:39], 0 offen offset:24
    buffer_load_ushort v147, v2, s[96:99], 0 offen offset:24
    s_mov_b64 exec, -1
    s_nop 0
    s_mov_b32 s36, s12
    s_and_b32 s37, s13, 0xffff
    s_mov_b32 s38, 0x40
    s_mov_b32 s39, 0x00020000
    s_mov_b32 s96, s20
    s_and_b32 s97, s21, 0xffff
    s_mov_b32 s98, 0x40
    s_mov_b32 s99, 0x00020000
    v_mov_b32 v4, 0
    buffer_load_ushort v148, v4, s[36:39], 0 offen
    buffer_load_ushort v149, v4, s[96:99], 0 offen
    s_waitcnt vmcnt(22)
    s_barrier
    s_waitcnt vmcnt(18)
    s_barrier
    s_barrier
    s_branch L_varj
L_var1:
    s_add_u32 m0, s56, 0x14000
    s_nop 0
    buffer_load_dwordx4 v14, s[28:31], 0 offen lds
    s_add_u32 m0, s56, 0x14400
    s_nop 0
    buffer_load_dwordx4 v42, s[28:31], 0 offen lds
    s_add_u32 m0, s56, 0x14800
    s_nop 0
    buffer_load_dwordx4 v70, s[28:31], 0 offen lds
    s_add_u32 m0, s56, 0x14c00
    s_nop 0
    buffer_load_dwordx4 v98, s[28:31], 0 offen lds
    s_add_u32 m0, s56, 0x18000
    s_nop 0
    buffer_load_dwordx4 v15, s[28:31], 0 offen lds
    s_add_u32 m0, s56, 0x18400
    s_nop 0
    buffer_load_dwordx4 v43, s[28:31], 0 offen lds
    s_add_u32 m0, s56, 0x18800
    s_nop 0
    buffer_load_dwordx4 v71, s[28:31], 0 offen lds
    s_add_u32 m0, s56, 0x18c00
    s_nop 0
    buffer_load_dwordx4 v99, s[28:31], 0 offen lds
    s_waitcnt vmcnt(8)
    s_barrier
    s_add_u32 s62, s100, 0x0
    s_sub_u32 s101, s62, 0xc0000
    s_cselect_b32 s62, s62, s101
    s_add_u32 s62, s62, s94
    s_add_u32 s62, s62, 0x10000
    s_add_u32 m0, s56, 0x4000
    s_nop 0
    buffer_load_dwordx4 v6, s[32:35], s62 offen lds
    s_add_u32 m0, s56, 0x4400
    s_nop 0
    buffer_load_dwordx4 v7, s[32:35], s62 offen lds
    s_add_u32 m0, s56, 0x4800
    s_nop 0
    buffer_load_dwordx4 v8, s[32:35], s62 offen lds
    s_add_u32 m0, s56, 0x4c00
    s_nop 0
    buffer_load_dwordx4 v9, s[32:35], s62 offen lds
    s_add_u32 s62, s100, 0x0
    s_sub_u32 s101, s62, 0xc0000
    s_cselect_b32 s62, s62, s101
    s_add_u32 s62, s62, s94
    s_add_u32 s62, s62, 0x18000
    s_add_u32 m0, s56, 0x8000
    s_nop 0
    buffer_load_dwordx4 v6, s[32:35], s62 offen lds
    s_add_u32 m0, s56, 0x8400
    s_nop 0
    buffer_load_dwordx4 v7, s[32:35], s62 offen lds
    s_add_u32 m0, s56, 0x8800
    s_nop 0
    buffer_load_dwordx4 v8, s[32:35], s62 offen lds
    s_add_u32 m0, s56, 0x8c00
    s_nop 0
    buffer_load_dwordx4 v9, s[32:35], s62 offen lds
    s_add_u32 m0, s56, 0x1c000
    s_nop 0
    buffer_load_dwordx4 v12, s[28:31], 0 offen lds
    s_add_u32 m0, s56, 0x1c400
    s_nop 0
    buffer_load_dwordx4 v40, s[28:31], 0 offen lds
    s_add_u32 m0, s56, 0x1c800
    s_nop 0
    buffer_load_dwordx4 v68, s[28:31], 0 offen lds
    s_add_u32 m0, s56, 0x1cc00
    s_nop 0
    buffer_load_dwordx4 v96, s[28:31], 0 offen lds
    s_waitcnt vmcnt(8)
    s_barrier
    s_add_u32 m0, s56, 0x20000
    s_nop 0
    buffer_load_dwordx4 v13, s[28:31], 0 offen lds
    s_add_u32 m0, s56, 0x20400
    s_nop 0
    buffer_load_dwordx4 v41, s[28:31], 0 offen lds
    s_add_u32 m0, s56, 0x20800
    s_nop 0
    buffer_load_dwordx4 v69, s[28:31], 0 offen lds
    s_add_u32 m0, s56, 0x20c00
    s_nop 0
    buffer_load_dwordx4 v97, s[28:31], 0 offen lds
    s_add_u32 s62, s100, 0x0
    s_sub_u32 s101, s62, 0xc0000
    s_cselect_b32 s62, s62, s101
    s_add_u32 s62, s62, s94
    s_add_u32 m0, s56, 0xc000
    s_nop 0
    buffer_load_dwordx4 v6, s[32:35], s62 offen lds
    s_add_u32 m0, s56, 0xc400
    s_nop 0
    buffer_load_dwordx4 v7, s[32:35], s62 offen lds
    s_add_u32 m0, s56, 0xc800
    s_nop 0
    buffer_load_dwordx4 v8, s[32:35], s62 offen lds
    s_add_u32 m0, s56, 0xcc00
    s_nop 0
    buffer_load_dwordx4 v9, s[32:35], s62 offen lds
    s_add_u32 s62, s100, 0x0
    s_sub_u32 s101, s62, 0xc0000
    s_cselect_b32 s62, s62, s101
    s_add_u32 s62, s62, s94
    s_add_u32 s62, s62, 0x8000
    s_add_u32 m0, s56, 0x0
    s_nop 0
    buffer_load_dwordx4 v6, s[32:35], s62 offen lds
    s_add_u32 m0, s56, 0x400
    s_nop 0
    buffer_load_dwordx4 v7, s[32:35], s62 offen lds
    s_add_u32 m0, s56, 0x800
    s_nop 0
    buffer_load_dwordx4 v8, s[32:35], s62 offen lds
    s_add_u32 m0, s56, 0xc00
    s_nop 0
    buffer_load_dwordx4 v9, s[32:35], s62 offen lds
    s_waitcnt vmcnt(16)
    s_barrier
    s_add_u32 m0, s56, 0x24000
    s_nop 0
    buffer_load_dwordx4 v18, s[28:31], 0 offen lds
    s_add_u32 m0, s56, 0x24400
    s_nop 0
    buffer_load_dwordx4 v46, s[28:31], 0 offen lds
    s_add_u32 m0, s56, 0x24800
    s_nop 0
    buffer_load_dwordx4 v74, s[28:31], 0 offen lds
    s_add_u32 m0, s56, 0x24c00
    s_nop 0
    buffer_load_dwordx4 v102, s[28:31], 0 offen lds
    s_add_u32 m0, s56, 0x10000
    s_nop 0
    buffer_load_dwordx4 v19, s[28:31], 0 offen lds
    s_add_u32 m0, s56, 0x10400
    s_nop 0
    buffer_load_dwordx4 v47, s[28:31], 0 offen lds
    s_add_u32 m0, s56, 0x10800
    s_nop 0
    buffer_load_dwordx4 v75, s[28:31], 0 offen lds
    s_add_u32 m0, s56, 0x10c00
    s_nop 0
    buffer_load_dwordx4 v103, s[28:31], 0 offen lds
    s_add_u32 s62, s100, 0x20000
    s_sub_u32 s101, s62, 0xc0000
    s_cselect_b32 s62, s62, s101
    s_add_u32 s62, s62, s94
    s_add_u32 s62, s62, 0x10000
    s_add_u32 m0, s56, 0x4000
    s_nop 0
    buffer_load_dwordx4 v6, s[32:35], s62 offen lds
    s_add_u32 m0, s56, 0x4400
    s_nop 0
    buffer_load_dwordx4 v7, s[32:35], s62 offen lds
    s_add_u32 m0, s56, 0x4800
    s_nop 0
    buffer_load_dwordx4 v8, s[32:35], s62 offen lds
    s_add_u32 m0, s56, 0x4c00
    s_nop 0
    buffer_load_dwordx4 v9, s[32:35], s62 offen lds
    s_waitcnt vmcnt(16)
    s_barrier
    s_add_u32 s62, s100, 0x20000
    s_sub_u32 s101, s62, 0xc0000
    s_cselect_b32 s62, s62, s101
    s_add_u32 s62, s62, s94
    s_add_u32 s62, s62, 0x18000
    s_add_u32 m0, s56, 0x8000
    s_nop 0
    buffer_load_dwordx4 v6, s[32:35], s62 offen lds
    s_add_u32 m0, s56, 0x8400
    s_nop 0
    buffer_load_dwordx4 v7, s[32:35], s62 offen lds
    s_add_u32 m0, s56, 0x8800
    s_nop 0
    buffer_load_dwordx4 v8, s[32:35], s62 offen lds
    s_add_u32 m0, s56, 0x8c00
    s_nop 0
    buffer_load_dwordx4 v9, s[32:35], s62 offen lds
    s_add_u32 m0, s56, 0x14000
    s_nop 0
    buffer_load_dwordx4 v16, s[28:31], 0 offen lds
    s_add_u32 m0, s56, 0x14400
    s_nop 0
    buffer_load_dwordx4 v44, s[28:31], 0 offen lds
    s_add_u32 m0, s56, 0x14800
    s_nop 0
    buffer_load_dwordx4 v72, s[28:31], 0 offen lds
    s_add_u32 m0, s56, 0x14c00
    s_nop 0
    buffer_load_dwordx4 v100, s[28:31], 0 offen lds
    s_add_u32 m0, s56, 0x18000
    s_nop 0
    buffer_load_dwordx4 v17, s[28:31], 0 offen lds
    s_add_u32 m0, s56, 0x18400
    s_nop 0
    buffer_load_dwordx4 v45, s[28:31], 0 offen lds
    s_add_u32 m0, s56, 0x18800
    s_nop 0
    buffer_load_dwordx4 v73, s[28:31], 0 offen lds
    s_add_u32 m0, s56, 0x18c00
    s_nop 0
    buffer_load_dwordx4 v101, s[28:31], 0 offen lds
    s_cmp_lg_u32 s55, 0
    s_cbranch_scc1 L_nordy1
    v_mov_b32 v2, s63
    s_mov_b64 exec, 1
    buffer_store_byte v152, v2, s[44:47], 0 offen sc1
    s_mov_b64 exec, -1
L_nordy1:
    s_waitcnt vmcnt(24)
    s_barrier
    s_add_u32 s62, s100, 0x20000
    s_sub_u32 s101, s62, 0xc0000
    s_cselect_b32 s62, s62, s101
    s_add_u32 s62, s62, s94
    s_add_u32 m0, s56, 0xc000
    s_nop 0
    buffer_load_dwordx4 v6, s[32:35], s62 offen lds
    s_add_u32 m0, s56, 0xc400
    s_nop 0
    buffer_load_dwordx4 v7, s[32:35], s62 offen lds
    s_add_u32 m0, s56, 0xc800
    s_nop 0
    buffer_load_dwordx4 v8, s[32:35], s62 offen lds
    s_add_u32 m0, s56, 0xcc00
    s_nop 0
    buffer_load_dwordx4 v9, s[32:35], s62 offen lds
    s_waitcnt vmcnt(16)
    s_barrier
    s_add_u32 s62, s100, 0x20000
    s_sub_u32 s101, s62, 0xc0000
    s_cselect_b32 s62, s62, s101
    s_add_u32 s62, s62, s94
    s_add_u32 s62, s62, 0x8000
    s_add_u32 m0, s56, 0x0
    s_nop 0
    buffer_load_dwordx4 v6, s[32:35], s62 offen lds
    s_add_u32 m0, s56, 0x400
    s_nop 0
    buffer_load_dwordx4 v7, s[32:35], s62 offen lds
    s_add_u32 m0, s56, 0x800
    s_nop 0
    buffer_load_dwordx4 v8, s[32:35], s62 offen lds
    s_add_u32 m0, s56, 0xc00
    s_nop 0
    buffer_load_dwordx4 v9, s[32:35], s62 offen lds
    s_add_u32 m0, s56, 0x1c000
    s_nop 0
    buffer_load_dwordx4 v22, s[28:31], 0 offen lds
    s_add_u32 m0, s56, 0x1c400
    s_nop 0
    buffer_load_dwordx4 v50, s[28:31], 0 offen lds
    s_add_u32 m0, s56, 0x1c800
    s_nop 0
    buffer_load_dwordx4 v78, s[28:31], 0 offen lds
    s_add_u32 m0, s56, 0x1cc00
    s_nop 0
    buffer_load_dwordx4 v106, s[28:31], 0 offen lds
    s_waitcnt vmcnt(20)
    s_barrier
    s_add_u32 m0, s56, 0x20000
    s_nop 0
    buffer_load_dwordx4 v23, s[28:31], 0 offen lds
    s_add_u32 m0, s56, 0x20400
    s_nop 0
    buffer_load_dwordx4 v51, s[28:31], 0 offen lds
    s_add_u32 m0, s56, 0x20800
    s_nop 0
    buffer_load_dwordx4 v79, s[28:31], 0 offen lds
    s_add_u32 m0, s56, 0x20c00
    s_nop 0
    buffer_load_dwordx4 v107, s[28:31], 0 offen lds
    s_add_u32 s62, s100, 0x40000
    s_sub_u32 s101, s62, 0xc0000
    s_cselect_b32 s62, s62, s101
    s_add_u32 s62, s62, s94
    s_add_u32 s62, s62, 0x10000
    s_add_u32 m0, s56, 0x4000
    s_nop 0
    buffer_load_dwordx4 v6, s[32:35], s62 offen lds
    s_add_u32 m0, s56, 0x4400
    s_nop 0
    buffer_load_dwordx4 v7, s[32:35], s62 offen lds
    s_add_u32 m0, s56, 0x4800
    s_nop 0
    buffer_load_dwordx4 v8, s[32:35], s62 offen lds
    s_add_u32 m0, s56, 0x4c00
    s_nop 0
    buffer_load_dwordx4 v9, s[32:35], s62 offen lds
    s_waitcnt vmcnt(16)
    s_barrier
    s_add_u32 s62, s100, 0x40000
    s_sub_u32 s101, s62, 0xc0000
    s_cselect_b32 s62, s62, s101
    s_add_u32 s62, s62, s94
    s_add_u32 s62, s62, 0x18000
    s_add_u32 m0, s56, 0x8000
    s_nop 0
    buffer_load_dwordx4 v6, s[32:35], s62 offen lds
    s_add_u32 m0, s56, 0x8400
    s_nop 0
    buffer_load_dwordx4 v7, s[32:35], s62 offen lds
    s_add_u32 m0, s56, 0x8800
    s_nop 0
    buffer_load_dwordx4 v8, s[32:35], s62 offen lds
    s_add_u32 m0, s56, 0x8c00
    s_nop 0
    buffer_load_dwordx4 v9, s[32:35], s62 offen lds
    s_add_u32 m0, s56, 0x24000
    s_nop 0
    buffer_load_dwordx4 v20, s[28:31], 0 offen lds
    s_add_u32 m0, s56, 0x24400
    s_nop 0
    buffer_load_dwordx4 v48, s[28:31], 0 offen lds
    s_add_u32 m0, s56, 0x24800
    s_nop 0
    buffer_load_dwordx4 v76, s[28:31], 0 offen lds
    s_add_u32 m0, s56, 0x24c00
    s_nop 0
    buffer_load_dwordx4 v104, s[28:31], 0 offen lds
    s_waitcnt vmcnt(20)
    s_barrier
    s_add_u32 m0, s56, 0x10000
    s_nop 0
    buffer_load_dwordx4 v21, s[28:31], 0 offen lds
    s_add_u32 m0, s56, 0x10400
    s_nop 0
    buffer_load_dwordx4 v49, s[28:31], 0 offen lds
    s_add_u32 m0, s56, 0x10800
    s_nop 0
    buffer_load_dwordx4 v77, s[28:31], 0 offen lds
    s_add_u32 m0, s56, 0x10c00
    s_nop 0
    buffer_load_dwordx4 v105, s[28:31], 0 offen lds
    s_add_u32 s62, s100, 0x40000
    s_sub_u32 s101, s62, 0xc0000
    s_cselect_b32 s62, s62, s101
    s_add_u32 s62, s62, s94
    s_add_u32 m0, s56, 0xc000
    s_nop 0
    buffer_load_dwordx4 v6, s[32:35], s62 offen lds
    s_add_u32 m0, s56, 0xc400
    s_nop 0
    buffer_load_dwordx4 v7, s[32:35], s62 offen lds
    s_add_u32 m0, s56, 0xc800
    s_nop 0
    buffer_load_dwordx4 v8, s[32:35], s62 offen lds
    s_add_u32 m0, s56, 0xcc00
    s_nop 0
    buffer_load_dwordx4 v9, s[32:35], s62 offen lds
    s_waitcnt vmcnt(16)
    s_barrier
    s_add_u32 s62, s100, 0x40000
    s_sub_u32 s101, s62, 0xc0000
    s_cselect_b32 s62, s62, s101
    s_add_u32 s62, s62, s94
    s_add_u32 s62, s62, 0x8000
    s_add_u32 m0, s56, 0x0
    s_nop 0
    buffer_load_dwordx4 v6, s[32:35], s62 offen lds
    s_add_u32 m0, s56, 0x400
    s_nop 0
    buffer_load_dwordx4 v7, s[32:35], s62 offen lds
    s_add_u32 m0, s56, 0x800
    s_nop 0
    buffer_load_dwordx4 v8, s[32:35], s62 offen lds
    s_add_u32 m0, s56, 0xc00
    s_nop 0
    buffer_load_dwordx4 v9, s[32:35], s62 offen lds
    s_add_u32 m0, s56, 0x14000
    s_nop 0
    buffer_load_dwordx4 v26, s[28:31], 0 offen lds
    s_add_u32 m0, s56, 0x14400
    s_nop 0
    buffer_load_dwordx4 v54, s[28:31], 0 offen lds
    s_add_u32 m0, s56, 0x14800
    s_nop 0
    buffer_load_dwordx4 v82, s[28:31], 0 offen lds
    s_add_u32 m0, s56, 0x14c00
    s_nop 0
    buffer_load_dwordx4 v110, s[28:31], 0 offen lds
    s_waitcnt vmcnt(20)
    s_barrier
    s_add_u32 m0, s56, 0x18000
    s_nop 0
    buffer_load_dwordx4 v27, s[28:31], 0 offen lds
    s_add_u32 m0, s56, 0x18400
    s_nop 0
    buffer_load_dwordx4 v55, s[28:31], 0 offen lds
    s_add_u32 m0, s56, 0x18800
    s_nop 0
    buffer_load_dwordx4 v83, s[28:31], 0 offen lds
    s_add_u32 m0, s56, 0x18c00
    s_nop 0
    buffer_load_dwordx4 v111, s[28:31], 0 offen lds
    s_add_u32 s62, s100, 0x60000
    s_sub_u32 s101, s62, 0xc0000
    s_cselect_b32 s62, s62, s101
    s_add_u32 s62, s62, s94
    s_add_u32 s62, s62, 0x10000
    s_add_u32 m0, s56, 0x4000
    s_nop 0
    buffer_load_dwordx4 v6, s[32:35], s62 offen lds
    s_add_u32 m0, s56, 0x4400
    s_nop 0
    buffer_load_dwordx4 v7, s[32:35], s62 offen lds
    s_add_u32 m0, s56, 0x4800
    s_nop 0
    buffer_load_dwordx4 v8, s[32:35], s62 offen lds
    s_add_u32 m0, s56, 0x4c00
    s_nop 0
    buffer_load_dwordx4 v9, s[32:35], s62 offen lds
    s_waitcnt vmcnt(16)
    s_barrier
    s_add_u32 s62, s100, 0x60000
    s_sub_u32 s101, s62, 0xc0000
    s_cselect_b32 s62, s62, s101
    s_add_u32 s62, s62, s94
    s_add_u32 s62, s62, 0x18000
    s_add_u32 m0, s56, 0x8000
    s_nop 0
    buffer_load_dwordx4 v6, s[32:35], s62 offen lds
    s_add_u32 m0, s56, 0x8400
    s_nop 0
    buffer_load_dwordx4 v7, s[32:35], s62 offen lds
    s_add_u32 m0, s56, 0x8800
    s_nop 0
    buffer_load_dwordx4 v8, s[32:35], s62 offen lds
    s_add_u32 m0, s56, 0x8c00
    s_nop 0
    buffer_load_dwordx4 v9, s[32:35], s62 offen lds
    s_add_u32 m0, s56, 0x1c000
    s_nop 0
    buffer_load_dwordx4 v24, s[28:31], 0 offen lds
    s_add_u32 m0, s56, 0x1c400
    s_nop 0
    buffer_load_dwordx4 v52, s[28:31], 0 offen lds
    s_add_u32 m0, s56, 0x1c800
    s_nop 0
    buffer_load_dwordx4 v80, s[28:31], 0 offen lds
    s_add_u32 m0, s56, 0x1cc00
    s_nop 0
    buffer_load_dwordx4 v108, s[28:31], 0 offen lds
    s_waitcnt vmcnt(20)
    s_barrier
    s_add_u32 m0, s56, 0x20000
    s_nop 0
    buffer_load_dwordx4 v25, s[28:31], 0 offen lds
    s_add_u32 m0, s56, 0x20400
    s_nop 0
    buffer_load_dwordx4 v53, s[28:31], 0 offen lds
    s_add_u32 m0, s56, 0x20800
    s_nop 0
    buffer_load_dwordx4 v81, s[28:31], 0 offen lds
    s_add_u32 m0, s56, 0x20c00
    s_nop 0
    buffer_load_dwordx4 v109, s[28:31], 0 offen lds
    s_add_u32 s62, s100, 0x60000
    s_sub_u32 s101, s62, 0xc0000
    s_cselect_b32 s62, s62, s101
    s_add_u32 s62, s62, s94
    s_add_u32 m0, s56, 0xc000
    s_nop 0
    buffer_load_dwordx4 v6, s[32:35], s62 offen lds
    s_add_u32 m0, s56, 0xc400
    s_nop 0
    buffer_load_dwordx4 v7, s[32:35], s62 offen lds
    s_add_u32 m0, s56, 0xc800
    s_nop 0
    buffer_load_dwordx4 v8, s[32:35], s62 offen lds
    s_add_u32 m0, s56, 0xcc00
    s_nop 0
    buffer_load_dwordx4 v9, s[32:35], s62 offen lds
    s_waitcnt vmcnt(16)
    s_barrier
    s_add_u32 s62, s100, 0x60000
    s_sub_u32 s101, s62, 0xc0000
    s_cselect_b32 s62, s62, s101
    s_add_u32 s62, s62, s94
    s_add_u32 s62, s62, 0x8000
    s_add_u32 m0, s56, 0x0
    s_nop 0
    buffer_load_dwordx4 v6, s[32:35], s62 offen lds
    s_add_u32 m0, s56, 0x400
    s_nop 0
    buffer_load_dwordx4 v7, s[32:35], s62 offen lds
    s_add_u32 m0, s56, 0x800
    s_nop 0
    buffer_load_dwordx4 v8, s[32:35], s62 offen lds
    s_add_u32 m0, s56, 0xc00
    s_nop 0
    buffer_load_dwordx4 v9, s[32:35], s62 offen lds
    s_add_u32 m0, s56, 0x24000
    s_nop 0
    buffer_load_dwordx4 v30, s[28:31], 0 offen lds
    s_add_u32 m0, s56, 0x24400
    s_nop 0
    buffer_load_dwordx4 v58, s[28:31], 0 offen lds
    s_add_u32 m0, s56, 0x24800
    s_nop 0
    buffer_load_dwordx4 v86, s[28:31], 0 offen lds
    s_add_u32 m0, s56, 0x24c00
    s_nop 0
    buffer_load_dwordx4 v114, s[28:31], 0 offen lds
    s_waitcnt vmcnt(20)
    s_barrier
    s_add_u32 m0, s56, 0x10000
    s_nop 0
    buffer_load_dwordx4 v31, s[28:31], 0 offen lds
    s_add_u32 m0, s56, 0x10400
    s_nop 0
    buffer_load_dwordx4 v59, s[28:31], 0 offen lds
    s_add_u32 m0, s56, 0x10800
    s_nop 0
    buffer_load_dwordx4 v87, s[28:31], 0 offen lds
    s_add_u32 m0, s56, 0x10c00
    s_nop 0
    buffer_load_dwordx4 v115, s[28:31], 0 offen lds
    s_add_u32 s62, s100, 0x80000
    s_sub_u32 s101, s62, 0xc0000
    s_cselect_b32 s62, s62, s101
    s_add_u32 s62, s62, s94
    s_add_u32 s62, s62, 0x10000
    s_add_u32 m0, s56, 0x4000
    s_nop 0
    buffer_load_dwordx4 v6, s[32:35], s62 offen lds
    s_add_u32 m0, s56, 0x4400
    s_nop 0
    buffer_load_dwordx4 v7, s[32:35], s62 offen lds
    s_add_u32 m0, s56, 0x4800
    s_nop 0
    buffer_load_dwordx4 v8, s[32:35], s62 offen lds
    s_add_u32 m0, s56, 0x4c00
    s_nop 0
    buffer_load_dwordx4 v9, s[32:35], s62 offen lds
    s_waitcnt vmcnt(16)
    s_barrier
    s_add_u32 s62, s100, 0x80000
    s_sub_u32 s101, s62, 0xc0000
    s_cselect_b32 s62, s62, s101
    s_add_u32 s62, s62, s94
    s_add_u32 s62, s62, 0x18000
    s_add_u32 m0, s56, 0x8000
    s_nop 0
    buffer_load_dwordx4 v6, s[32:35], s62 offen lds
    s_add_u32 m0, s56, 0x8400
    s_nop 0
    buffer_load_dwordx4 v7, s[32:35], s62 offen lds
    s_add_u32 m0, s56, 0x8800
    s_nop 0
    buffer_load_dwordx4 v8, s[32:35], s62 offen lds
    s_add_u32 m0, s56, 0x8c00
    s_nop 0
    buffer_load_dwordx4 v9, s[32:35], s62 offen lds
    s_add_u32 m0, s56, 0x14000
    s_nop 0
    buffer_load_dwordx4 v28, s[28:31], 0 offen lds
    s_add_u32 m0, s56, 0x14400
    s_nop 0
    buffer_load_dwordx4 v56, s[28:31], 0 offen lds
    s_add_u32 m0, s56, 0x14800
    s_nop 0
    buffer_load_dwordx4 v84, s[28:31], 0 offen lds
    s_add_u32 m0, s56, 0x14c00
    s_nop 0
    buffer_load_dwordx4 v112, s[28:31], 0 offen lds
    s_waitcnt vmcnt(20)
    s_barrier
    s_add_u32 m0, s56, 0x18000
    s_nop 0
    buffer_load_dwordx4 v29, s[28:31], 0 offen lds
    s_add_u32 m0, s56, 0x18400
    s_nop 0
    buffer_load_dwordx4 v57, s[28:31], 0 offen lds
    s_add_u32 m0, s56, 0x18800
    s_nop 0
    buffer_load_dwordx4 v85, s[28:31], 0 offen lds
    s_add_u32 m0, s56, 0x18c00
    s_nop 0
    buffer_load_dwordx4 v113, s[28:31], 0 offen lds
    s_add_u32 s62, s100, 0x80000
    s_sub_u32 s101, s62, 0xc0000
    s_cselect_b32 s62, s62, s101
    s_add_u32 s62, s62, s94
    s_add_u32 m0, s56, 0xc000
    s_nop 0
    buffer_load_dwordx4 v6, s[32:35], s62 offen lds
    s_add_u32 m0, s56, 0xc400
    s_nop 0
    buffer_load_dwordx4 v7, s[32:35], s62 offen lds
    s_add_u32 m0, s56, 0xc800
    s_nop 0
    buffer_load_dwordx4 v8, s[32:35], s62 offen lds
    s_add_u32 m0, s56, 0xcc00
    s_nop 0
    buffer_load_dwordx4 v9, s[32:35], s62 offen lds
    s_waitcnt vmcnt(16)
    s_barrier
    s_add_u32 s62, s100, 0x80000
    s_sub_u32 s101, s62, 0xc0000
    s_cselect_b32 s62, s62, s101
    s_add_u32 s62, s62, s94
    s_add_u32 s62, s62, 0x8000
    s_add_u32 m0, s56, 0x0
    s_nop 0
    buffer_load_dwordx4 v6, s[32:35], s62 offen lds
    s_add_u32 m0, s56, 0x400
    s_nop 0
    buffer_load_dwordx4 v7, s[32:35], s62 offen lds
    s_add_u32 m0, s56, 0x800
    s_nop 0
    buffer_load_dwordx4 v8, s[32:35], s62 offen lds
    s_add_u32 m0, s56, 0xc00
    s_nop 0
    buffer_load_dwordx4 v9, s[32:35], s62 offen lds
    s_add_u32 m0, s56, 0x1c000
    s_nop 0
    buffer_load_dwordx4 v34, s[28:31], 0 offen lds
    s_add_u32 m0, s56, 0x1c400
    s_nop 0
    buffer_load_dwordx4 v62, s[28:31], 0 offen lds
    s_add_u32 m0, s56, 0x1c800
    s_nop 0
    buffer_load_dwordx4 v90, s[28:31], 0 offen lds
    s_add_u32 m0, s56, 0x1cc00
    s_nop 0
    buffer_load_dwordx4 v118, s[28:31], 0 offen lds
    s_waitcnt vmcnt(20)
    s_barrier
    s_add_u32 m0, s56, 0x20000
    s_nop 0
    buffer_load_dwordx4 v35, s[28:31], 0 offen lds
    s_add_u32 m0, s56, 0x20400
    s_nop 0
    buffer_load_dwordx4 v63, s[28:31], 0 offen lds
    s_add_u32 m0, s56, 0x20800
    s_nop 0
    buffer_load_dwordx4 v91, s[28:31], 0 offen lds
    s_add_u32 m0, s56, 0x20c00
    s_nop 0
    buffer_load_dwordx4 v119, s[28:31], 0 offen lds
    s_add_u32 s62, s100, 0xa0000
    s_sub_u32 s101, s62, 0xc0000
    s_cselect_b32 s62, s62, s101
    s_add_u32 s62, s62, s94
    s_add_u32 s62, s62, 0x10000
    s_add_u32 m0, s56, 0x4000
    s_nop 0
    buffer_load_dwordx4 v6, s[32:35], s62 offen lds
    s_add_u32 m0, s56, 0x4400
    s_nop 0
    buffer_load_dwordx4 v7, s[32:35], s62 offen lds
    s_add_u32 m0, s56, 0x4800
    s_nop 0
    buffer_load_dwordx4 v8, s[32:35], s62 offen lds
    s_add_u32 m0, s56, 0x4c00
    s_nop 0
    buffer_load_dwordx4 v9, s[32:35], s62 offen lds
    s_waitcnt vmcnt(16)
    s_barrier
    s_add_u32 s62, s100, 0xa0000
    s_sub_u32 s101, s62, 0xc0000
    s_cselect_b32 s62, s62, s101
    s_add_u32 s62, s62, s94
    s_add_u32 s62, s62, 0x18000
    s_add_u32 m0, s56, 0x8000
    s_nop 0
    buffer_load_dwordx4 v6, s[32:35], s62 offen lds
    s_add_u32 m0, s56, 0x8400
    s_nop 0
    buffer_load_dwordx4 v7, s[32:35], s62 offen lds
    s_add_u32 m0, s56, 0x8800
    s_nop 0
    buffer_load_dwordx4 v8, s[32:35], s62 offen lds
    s_add_u32 m0, s56, 0x8c00
    s_nop 0
    buffer_load_dwordx4 v9, s[32:35], s62 offen lds
    s_add_u32 m0, s56, 0x24000
    s_nop 0
    buffer_load_dwordx4 v32, s[28:31], 0 offen lds
    s_add_u32 m0, s56, 0x24400
    s_nop 0
    buffer_load_dwordx4 v60, s[28:31], 0 offen lds
    s_add_u32 m0, s56, 0x24800
    s_nop 0
    buffer_load_dwordx4 v88, s[28:31], 0 offen lds
    s_add_u32 m0, s56, 0x24c00
    s_nop 0
    buffer_load_dwordx4 v116, s[28:31], 0 offen lds
    s_waitcnt vmcnt(20)
    s_barrier
    s_add_u32 m0, s56, 0x10000
    s_nop 0
    buffer_load_dwordx4 v33, s[28:31], 0 offen lds
    s_add_u32 m0, s56, 0x10400
    s_nop 0
    buffer_load_dwordx4 v61, s[28:31], 0 offen lds
    s_add_u32 m0, s56, 0x10800
    s_nop 0
    buffer_load_dwordx4 v89, s[28:31], 0 offen lds
    s_add_u32 m0, s56, 0x10c00
    s_nop 0
    buffer_load_dwordx4 v117, s[28:31], 0 offen lds
    s_add_u32 s62, s100, 0xa0000
    s_sub_u32 s101, s62, 0xc0000
    s_cselect_b32 s62, s62, s101
    s_add_u32 s62, s62, s94
    s_add_u32 m0, s56, 0xc000
    s_nop 0
    buffer_load_dwordx4 v6, s[32:35], s62 offen lds
    s_add_u32 m0, s56, 0xc400
    s_nop 0
    buffer_load_dwordx4 v7, s[32:35], s62 offen lds
    s_add_u32 m0, s56, 0xc800
    s_nop 0
    buffer_load_dwordx4 v8, s[32:35], s62 offen lds
    s_add_u32 m0, s56, 0xcc00
    s_nop 0
    buffer_load_dwordx4 v9, s[32:35], s62 offen lds
    s_waitcnt vmcnt(16)
    s_barrier
    s_add_u32 s62, s100, 0xa0000
    s_sub_u32 s101, s62, 0xc0000
    s_cselect_b32 s62, s62, s101
    s_add_u32 s62, s62, s94
    s_add_u32 s62, s62, 0x8000
    s_add_u32 m0, s56, 0x0
    s_nop 0
    buffer_load_dwordx4 v6, s[32:35], s62 offen lds
    s_add_u32 m0, s56, 0x400
    s_nop 0
    buffer_load_dwordx4 v7, s[32:35], s62 offen lds
    s_add_u32 m0, s56, 0x800
    s_nop 0
    buffer_load_dwordx4 v8, s[32:35], s62 offen lds
    s_add_u32 m0, s56, 0xc00
    s_nop 0
    buffer_load_dwordx4 v9, s[32:35], s62 offen lds
    s_waitcnt vmcnt(16)
    s_barrier
    s_mov_b32 s36, s16
    s_and_b32 s37, s17, 0xffff
    s_mov_b32 s38, 0x200
    s_mov_b32 s39, 0x00020000
    s_mov_b32 s96, s18
    s_and_b32 s97, s19, 0xffff
    s_mov_b32 s98, 0x200
    s_mov_b32 s99, 0x00020000
    s_lshl_b32 s59, s55, 6
    v_lshrrev_b32 v2, 4, v1
    v_lshlrev_b32 v2, 3, v2
    buffer_load_dwordx2 v[124:125], v2, s[36:39], s59 offen offset:0
    buffer_load_dwordx2 v[132:133], v2, s[96:99], s59 offen offset:0
    buffer_load_dwordx2 v[126:127], v2, s[36:39], s59 offen offset:32
    buffer_load_dwordx2 v[134:135], v2, s[96:99], s59 offen offset:32
    buffer_load_dwordx2 v[128:129], v2, s[36:39], s59 offen offset:256
    buffer_load_dwordx2 v[136:137], v2, s[96:99], s59 offen offset:256
    buffer_load_dwordx2 v[130:131], v2, s[36:39], s59 offen offset:288
    buffer_load_dwordx2 v[138:139], v2, s[96:99], s59 offen offset:288
    s_nop 0
    s_mov_b32 s36, s8
    s_and_b32 s37, s9, 0xffff
    s_mov_b32 s38, 0x1a040
    s_mov_b32 s39, 0x00020000
    s_mov_b32 s96, s10
    s_and_b32 s97, s11, 0xffff
    s_mov_b32 s98, 0x40
    s_mov_b32 s99, 0x00020000
    v_and_b32 v3, 15, v1
    s_lshl_b32 s59, s63, 4
    v_add_u32 v3, s59, v3
    v_mul_u32_u24 v3, 26, v3
    v_lshrrev_b32 v2, 2, v2
    v_add_u32 v3, v3, v2
    buffer_load_ushort v140, v3, s[36:39], 0 offen offset:0
    buffer_load_ushort v144, v2, s[96:99], 0 offen offset:0
    buffer_load_ushort v141, v3, s[36:39], 0 offen offset:8
    buffer_load_ushort v145, v2, s[96:99], 0 offen offset:8
    buffer_load_ushort v142, v3, s[36:39], 0 offen offset:16
    buffer_load_ushort v146, v2, s[96:99], 0 offen offset:16
    v_mov_b32 v143, 0
    v_mov_b32 v147, 0
    s_mov_b64 exec, 0xffff
    buffer_load_ushort v143, v3, s[36:39], 0 offen offset:24
    buffer_load_ushort v147, v2, s[96:99], 0 offen offset:24
    s_mov_b64 exec, -1
    s_nop 0
    s_mov_b32 s36, s12
    s_and_b32 s37, s13, 0xffff
    s_mov_b32 s38, 0x40
    s_mov_b32 s39, 0x00020000
    s_mov_b32 s96, s20
    s_and_b32 s97, s21, 0xffff
    s_mov_b32 s98, 0x40
    s_mov_b32 s99, 0x00020000
    v_mov_b32 v4, 0
    buffer_load_ushort v148, v4, s[36:39], 0 offen
    buffer_load_ushort v149, v4, s[96:99], 0 offen
    s_waitcnt vmcnt(22)
    s_barrier
    s_waitcnt vmcnt(18)
    s_barrier
    s_barrier
    s_branch L_varj
L_var2:
    s_add_u32 m0, s56, 0x14000
    s_nop 0
    buffer_load_dwordx4 v12, s[28:31], 0 offen lds
    s_add_u32 m0, s56, 0x14400
    s_nop 0
    buffer_load_dwordx4 v40, s[28:31], 0 offen lds
    s_add_u32 m0, s56, 0x14800
    s_nop 0
    buffer_load_dwordx4 v68, s[28:31], 0 offen lds
    s_add_u32 m0, s56, 0x14c00
    s_nop 0
    buffer_load_dwordx4 v96, s[28:31], 0 offen lds
    s_waitcnt vmcnt(4)
    s_barrier
    s_add_u32 s62, s100, 0x0
    s_sub_u32 s101, s62, 0xc0000
    s_cselect_b32 s62, s62, s101
    s_add_u32 s62, s62, s94
    s_add_u32 m0, s56, 0x4000
    s_nop 0
    buffer_load_dwordx4 v6, s[32:35], s62 offen lds
    s_add_u32 m0, s56, 0x4400
    s_nop 0
    buffer_load_dwordx4 v7, s[32:35], s62 offen lds
    s_add_u32 m0, s56, 0x4800
    s_nop 0
    buffer_load_dwordx4 v8, s[32:35], s62 offen lds
    s_add_u32 m0, s56, 0x4c00
    s_nop 0
    buffer_load_dwordx4 v9, s[32:35], s62 offen lds
    s_add_u32 m0, s56, 0x18000
    s_nop 0
    buffer_load_dwordx4 v13, s[28:31], 0 offen lds
    s_add_u32 m0, s56, 0x18400
    s_nop 0
    buffer_load_dwordx4 v41, s[28:31], 0 offen lds
    s_add_u32 m0, s56, 0x18800
    s_nop 0
    buffer_load_dwordx4 v69, s[28:31], 0 offen lds
    s_add_u32 m0, s56, 0x18c00
    s_nop 0
    buffer_load_dwordx4 v97, s[28:31], 0 offen lds
    s_add_u32 s62, s100, 0x0
    s_sub_u32 s101, s62, 0xc0000
    s_cselect_b32 s62, s62, s101
    s_add_u32 s62, s62, s94
    s_add_u32 s62, s62, 0x8000
    s_add_u32 m0, s56, 0x8000
    s_nop 0
    buffer_load_dwordx4 v6, s[32:35], s62 offen lds
    s_add_u32 m0, s56, 0x8400
    s_nop 0
    buffer_load_dwordx4 v7, s[32:35], s62 offen lds
    s_add_u32 m0, s56, 0x8800
    s_nop 0
    buffer_load_dwordx4 v8, s[32:35], s62 offen lds
    s_add_u32 m0, s56, 0x8c00
    s_nop 0
    buffer_load_dwordx4 v9, s[32:35], s62 offen lds
    s_waitcnt vmcnt(8)
    s_barrier
    s_add_u32 m0, s56, 0x1c000
    s_nop 0
    buffer_load_dwordx4 v14, s[28:31], 0 offen lds
    s_add_u32 m0, s56, 0x1c400
    s_nop 0
    buffer_load_dwordx4 v42, s[28:31], 0 offen lds
    s_add_u32 m0, s56, 0x1c800
    s_nop 0
    buffer_load_dwordx4 v70, s[28:31], 0 offen lds
    s_add_u32 m0, s56, 0x1cc00
    s_nop 0
    buffer_load_dwordx4 v98, s[28:31], 0 offen lds
    s_add_u32 m0, s56, 0x20000
    s_nop 0
    buffer_load_dwordx4 v15, s[28:31], 0 offen lds
    s_add_u32 m0, s56, 0x20400
    s_nop 0
    buffer_load_dwordx4 v43, s[28:31], 0 offen lds
    s_add_u32 m0, s56, 0x20800
    s_nop 0
    buffer_load_dwordx4 v71, s[28:31], 0 offen lds
    s_add_u32 m0, s56, 0x20c00
    s_nop 0
    buffer_load_dwordx4 v99, s[28:31], 0 offen lds
    s_add_u32 s62, s100, 0x0
    s_sub_u32 s101, s62, 0xc0000
    s_cselect_b32 s62, s62, s101
    s_add_u32 s62, s62, s94
    s_add_u32 s62, s62, 0x10000
    s_add_u32 m0, s56, 0xc000
    s_nop 0
    buffer_load_dwordx4 v6, s[32:35], s62 offen lds
    s_add_u32 m0, s56, 0xc400
    s_nop 0
    buffer_load_dwordx4 v7, s[32:35], s62 offen lds
    s_add_u32 m0, s56, 0xc800
    s_nop 0
    buffer_load_dwordx4 v8, s[32:35], s62 offen lds
    s_add_u32 m0, s56, 0xcc00
    s_nop 0
    buffer_load_dwordx4 v9, s[32:35], s62 offen lds
    s_waitcnt vmcnt(12)
    s_barrier
    s_add_u32 s62, s100, 0x0
    s_sub_u32 s101, s62, 0xc0000
    s_cselect_b32 s62, s62, s101
    s_add_u32 s62, s62, s94
    s_add_u32 s62, s62, 0x18000
    s_add_u32 m0, s56, 0x0
    s_nop 0
    buffer_load_dwordx4 v6, s[32:35], s62 offen lds
    s_add_u32 m0, s56, 0x400
    s_nop 0
    buffer_load_dwordx4 v7, s[32:35], s62 offen lds
    s_add_u32 m0, s56, 0x800
    s_nop 0
    buffer_load_dwordx4 v8, s[32:35], s62 offen lds
    s_add_u32 m0, s56, 0xc00
    s_nop 0
    buffer_load_dwordx4 v9, s[32:35], s62 offen lds
    s_add_u32 m0, s56, 0x24000
    s_nop 0
    buffer_load_dwordx4 v16, s[28:31], 0 offen lds
    s_add_u32 m0, s56, 0x24400
    s_nop 0
    buffer_load_dwordx4 v44, s[28:31], 0 offen lds
    s_add_u32 m0, s56, 0x24800
    s_nop 0
    buffer_load_dwordx4 v72, s[28:31], 0 offen lds
    s_add_u32 m0, s56, 0x24c00
    s_nop 0
    buffer_load_dwordx4 v100, s[28:31], 0 offen lds
    s_add_u32 m0, s56, 0x10000
    s_nop 0
    buffer_load_dwordx4 v17, s[28:31], 0 offen lds
    s_add_u32 m0, s56, 0x10400
    s_nop 0
    buffer_load_dwordx4 v45, s[28:31], 0 offen lds
    s_add_u32 m0, s56, 0x10800
    s_nop 0
    buffer_load_dwordx4 v73, s[28:31], 0 offen lds
    s_add_u32 m0, s56, 0x10c00
    s_nop 0
    buffer_load_dwordx4 v101, s[28:31], 0 offen lds
    s_waitcnt vmcnt(12)
    s_barrier
    s_add_u32 s62, s100, 0x20000
    s_sub_u32 s101, s62, 0xc0000
    s_cselect_b32 s62, s62, s101
    s_add_u32 s62, s62, s94
    s_add_u32 m0, s56, 0x4000
    s_nop 0
    buffer_load_dwordx4 v6, s[32:35], s62 offen lds
    s_add_u32 m0, s56, 0x4400
    s_nop 0
    buffer_load_dwordx4 v7, s[32:35], s62 offen lds
    s_add_u32 m0, s56, 0x4800
    s_nop 0
    buffer_load_dwordx4 v8, s[32:35], s62 offen lds
    s_add_u32 m0, s56, 0x4c00
    s_nop 0
    buffer_load_dwordx4 v9, s[32:35], s62 offen lds
    s_add_u32 s62, s100, 0x20000
    s_sub_u32 s101, s62, 0xc0000
    s_cselect_b32 s62, s62, s101
    s_add_u32 s62, s62, s94
    s_add_u32 s62, s62, 0x8000
    s_add_u32 m0, s56, 0x8000
    s_nop 0
    buffer_load_dwordx4 v6, s[32:35], s62 offen lds
    s_add_u32 m0, s56, 0x8400
    s_nop 0
    buffer_load_dwordx4 v7, s[32:35], s62 offen lds
    s_add_u32 m0, s56, 0x8800
    s_nop 0
    buffer_load_dwordx4 v8, s[32:35], s62 offen lds
    s_add_u32 m0, s56, 0x8c00
    s_nop 0
    buffer_load_dwordx4 v9, s[32:35], s62 offen lds
    s_add_u32 m0, s56, 0x14000
    s_nop 0
    buffer_load_dwordx4 v18, s[28:31], 0 offen lds
    s_add_u32 m0, s56, 0x14400
    s_nop 0
    buffer_load_dwordx4 v46, s[28:31], 0 offen lds
    s_add_u32 m0, s56, 0x14800
    s_nop 0
    buffer_load_dwordx4 v74, s[28:31], 0 offen lds
    s_add_u32 m0, s56, 0x14c00
    s_nop 0
    buffer_load_dwordx4 v102, s[28:31], 0 offen lds
    s_cmp_lg_u32 s55, 0
    s_cbranch_scc1 L_nordy2
    v_mov_b32 v2, s63
    s_mov_b64 exec, 1
    buffer_store_byte v152, v2, s[44:47], 0 offen sc1
    s_mov_b64 exec, -1
L_nordy2:
    s_waitcnt vmcnt(20)
    s_barrier
    s_add_u32 m0, s56, 0x18000
    s_nop 0
    buffer_load_dwordx4 v19, s[28:31], 0 offen lds
    s_add_u32 m0, s56, 0x18400
    s_nop 0
    buffer_load_dwordx4 v47, s[28:31], 0 offen lds
    s_add_u32 m0, s56, 0x18800
    s_nop 0
    buffer_load_dwordx4 v75, s[28:31], 0 offen lds
    s_add_u32 m0, s56, 0x18c00
    s_nop 0
    buffer_load_dwordx4 v103, s[28:31], 0 offen lds
    s_add_u32 s62, s100, 0x20000
    s_sub_u32 s101, s62, 0xc0000
    s_cselect_b32 s62, s62, s101
    s_add_u32 s62, s62, s94
    s_add_u32 s62, s62, 0x10000
    s_add_u32 m0, s56, 0xc000
    s_nop 0
    buffer_load_dwordx4 v6, s[32:35], s62 offen lds
    s_add_u32 m0, s56, 0xc400
    s_nop 0
    buffer_load_dwordx4 v7, s[32:35], s62 offen lds
    s_add_u32 m0, s56, 0xc800
    s_nop 0
    buffer_load_dwordx4 v8, s[32:35], s62 offen lds
    s_add_u32 m0, s56, 0xcc00
    s_nop 0
    buffer_load_dwordx4 v9, s[32:35], s62 offen lds
    s_waitcnt vmcnt(16)
    s_barrier
    s_add_u32 s62, s100, 0x20000
    s_sub_u32 s101, s62, 0xc0000
    s_cselect_b32 s62, s62, s101
    s_add_u32 s62, s62, s94
    s_add_u32 s62, s62, 0x18000
    s_add_u32 m0, s56, 0x0
    s_nop 0
    buffer_load_dwordx4 v6, s[32:35], s62 offen lds
    s_add_u32 m0, s56, 0x400
    s_nop 0
    buffer_load_dwordx4 v7, s[32:35], s62 offen lds
    s_add_u32 m0, s56, 0x800
    s_nop 0
    buffer_load_dwordx4 v8, s[32:35], s62 offen lds
    s_add_u32 m0, s56, 0xc00
    s_nop 0
    buffer_load_dwordx4 v9, s[32:35], s62 offen lds
    s_add_u32 m0, s56, 0x1c000
    s_nop 0
    buffer_load_dwordx4 v20, s[28:31], 0 offen lds
    s_add_u32 m0, s56, 0x1c400
    s_nop 0
    buffer_load_dwordx4 v48, s[28:31], 0 offen lds
    s_add_u32 m0, s56, 0x1c800
    s_nop 0
    buffer_load_dwordx4 v76, s[28:31], 0 offen lds
    s_add_u32 m0, s56, 0x1cc00
    s_nop 0
    buffer_load_dwordx4 v104, s[28:31], 0 offen lds
    s_waitcnt vmcnt(20)
    s_barrier
    s_add_u32 m0, s56, 0x20000
    s_nop 0
    buffer_load_dwordx4 v21, s[28:31], 0 offen lds
    s_add_u32 m0, s56, 0x20400
    s_nop 0
    buffer_load_dwordx4 v49, s[28:31], 0 offen lds
    s_add_u32 m0, s56, 0x20800
    s_nop 0
    buffer_load_dwordx4 v77, s[28:31], 0 offen lds
    s_add_u32 m0, s56, 0x20c00
    s_nop 0
    buffer_load_dwordx4 v105, s[28:31], 0 offen lds
    s_add_u32 s62, s100, 0x40000
    s_sub_u32 s101, s62, 0xc0000
    s_cselect_b32 s62, s62, s101
    s_add_u32 s62, s62, s94
    s_add_u32 m0, s56, 0x4000
    s_nop 0
    buffer_load_dwordx4 v6, s[32:35], s62 offen lds
    s_add_u32 m0, s56, 0x4400
    s_nop 0
    buffer_load_dwordx4 v7, s[32:35], s62 offen lds
    s_add_u32 m0, s56, 0x4800
    s_nop 0
    buffer_load_dwordx4 v8, s[32:35], s62 offen lds
    s_add_u32 m0, s56, 0x4c00
    s_nop 0
    buffer_load_dwordx4 v9, s[32:35], s62 offen lds
    s_waitcnt vmcnt(16)
    s_barrier
    s_add_u32 s62, s100, 0x40000
    s_sub_u32 s101, s62, 0xc0000
    s_cselect_b32 s62, s62, s101
    s_add_u32 s62, s62, s94
    s_add_u32 s62, s62, 0x8000
    s_add_u32 m0, s56, 0x8000
    s_nop 0
    buffer_load_dwordx4 v6, s[32:35], s62 offen lds
    s_add_u32 m0, s56, 0x8400
    s_nop 0
    buffer_load_dwordx4 v7, s[32:35], s62 offen lds
    s_add_u32 m0, s56, 0x8800
    s_nop 0
    buffer_load_dwordx4 v8, s[32:35], s62 offen lds
    s_add_u32 m0, s56, 0x8c00
    s_nop 0
    buffer_load_dwordx4 v9, s[32:35], s62 offen lds
    s_add_u32 m0, s56, 0x24000
    s_nop 0
    buffer_load_dwordx4 v22, s[28:31], 0 offen lds
    s_add_u32 m0, s56, 0x24400
    s_nop 0
    buffer_load_dwordx4 v50, s[28:31], 0 offen lds
    s_add_u32 m0, s56, 0x24800
    s_nop 0
    buffer_load_dwordx4 v78, s[28:31], 0 offen lds
    s_add_u32 m0, s56, 0x24c00
    s_nop 0
    buffer_load_dwordx4 v106, s[28:31], 0 offen lds
    s_waitcnt vmcnt(20)
    s_barrier
    s_add_u32 m0, s56, 0x10000
    s_nop 0
    buffer_load_dwordx4 v23, s[28:31], 0 offen lds
    s_add_u32 m0, s56, 0x10400
    s_nop 0
    buffer_load_dwordx4 v51, s[28:31], 0 offen lds
    s_add_u32 m0, s56, 0x10800
    s_nop 0
    buffer_load_dwordx4 v79, s[28:31], 0 offen lds
    s_add_u32 m0, s56, 0x10c00
    s_nop 0
    buffer_load_dwordx4 v107, s[28:31], 0 offen lds
    s_add_u32 s62, s100, 0x40000
    s_sub_u32 s101, s62, 0xc0000
    s_cselect_b32 s62, s62, s101
    s_add_u32 s62, s62, s94
    s_add_u32 s62, s62, 0x10000
    s_add_u32 m0, s56, 0xc000
    s_nop 0
    buffer_load_dwordx4 v6, s[32:35], s62 offen lds
    s_add_u32 m0, s56, 0xc400
    s_nop 0
    buffer_load_dwordx4 v7, s[32:35], s62 offen lds
    s_add_u32 m0, s56, 0xc800
    s_nop 0
    buffer_load_dwordx4 v8, s[32:35], s62 offen lds
    s_add_u32 m0, s56, 0xcc00
    s_nop 0
    buffer_load_dwordx4 v9, s[32:35], s62 offen lds
    s_waitcnt vmcnt(16)
    s_barrier
    s_add_u32 s62, s100, 0x40000
    s_sub_u32 s101, s62, 0xc0000
    s_cselect_b32 s62, s62, s101
    s_add_u32 s62, s62, s94
    s_add_u32 s62, s62, 0x18000
    s_add_u32 m0, s56, 0x0
    s_nop 0
    buffer_load_dwordx4 v6, s[32:35], s62 offen lds
    s_add_u32 m0, s56, 0x400
    s_nop 0
    buffer_load_dwordx4 v7, s[32:35], s62 offen lds
    s_add_u32 m0, s56, 0x800
    s_nop 0
    buffer_load_dwordx4 v8, s[32:35], s62 offen lds
    s_add_u32 m0, s56, 0xc00
    s_nop 0
    buffer_load_dwordx4 v9, s[32:35], s62 offen lds
    s_add_u32 m0, s56, 0x14000
    s_nop 0
    buffer_load_dwordx4 v24, s[28:31], 0 offen lds
    s_add_u32 m0, s56, 0x14400
    s_nop 0
    buffer_load_dwordx4 v52, s[28:31], 0 offen lds
    s_add_u32 m0, s56, 0x14800
    s_nop 0
    buffer_load_dwordx4 v80, s[28:31], 0 offen lds
    s_add_u32 m0, s56, 0x14c00
    s_nop 0
    buffer_load_dwordx4 v108, s[28:31], 0 offen lds
    s_waitcnt vmcnt(20)
    s_barrier
    s_add_u32 m0, s56, 0x18000
    s_nop 0
    buffer_load_dwordx4 v25, s[28:31], 0 offen lds
    s_add_u32 m0, s56, 0x18400
    s_nop 0
    buffer_load_dwordx4 v53, s[28:31], 0 offen lds
    s_add_u32 m0, s56, 0x18800
    s_nop 0
    buffer_load_dwordx4 v81, s[28:31], 0 offen lds
    s_add_u32 m0, s56, 0x18c00
    s_nop 0
    buffer_load_dwordx4 v109, s[28:31], 0 offen lds
    s_add_u32 s62, s100, 0x60000
    s_sub_u32 s101, s62, 0xc0000
    s_cselect_b32 s62, s62, s101
    s_add_u32 s62, s62, s94
    s_add_u32 m0, s56, 0x4000
    s_nop 0
    buffer_load_dwordx4 v6, s[32:35], s62 offen lds
    s_add_u32 m0, s56, 0x4400
    s_nop 0
    buffer_load_dwordx4 v7, s[32:35], s62 offen lds
    s_add_u32 m0, s56, 0x4800
    s_nop 0
    buffer_load_dwordx4 v8, s[32:35], s62 offen lds
    s_add_u32 m0, s56, 0x4c00
    s_nop 0
    buffer_load_dwordx4 v9, s[32:35], s62 offen lds
    s_waitcnt vmcnt(16)
    s_barrier
    s_add_u32 s62, s100, 0x60000
    s_sub_u32 s101, s62, 0xc0000
    s_cselect_b32 s62, s62, s101
    s_add_u32 s62, s62, s94
    s_add_u32 s62, s62, 0x8000
    s_add_u32 m0, s56, 0x8000
    s_nop 0
    buffer_load_dwordx4 v6, s[32:35], s62 offen lds
    s_add_u32 m0, s56, 0x8400
    s_nop 0
    buffer_load_dwordx4 v7, s[32:35], s62 offen lds
    s_add_u32 m0, s56, 0x8800
    s_nop 0
    buffer_load_dwordx4 v8, s[32:35], s62 offen lds
    s_add_u32 m0, s56, 0x8c00
    s_nop 0
    buffer_load_dwordx4 v9, s[32:35], s62 offen lds
    s_add_u32 m0, s56, 0x1c000
    s_nop 0
    buffer_load_dwordx4 v26, s[28:31], 0 offen lds
    s_add_u32 m0, s56, 0x1c400
    s_nop 0
    buffer_load_dwordx4 v54, s[28:31], 0 offen lds
    s_add_u32 m0, s56, 0x1c800
    s_nop 0
    buffer_load_dwordx4 v82, s[28:31], 0 offen lds
    s_add_u32 m0, s56, 0x1cc00
    s_nop 0
    buffer_load_dwordx4 v110, s[28:31], 0 offen lds
    s_waitcnt vmcnt(20)
    s_barrier
    s_add_u32 m0, s56, 0x20000
    s_nop 0
    buffer_load_dwordx4 v27, s[28:31], 0 offen lds
    s_add_u32 m0, s56, 0x20400
    s_nop 0
    buffer_load_dwordx4 v55, s[28:31], 0 offen lds
    s_add_u32 m0, s56, 0x20800
    s_nop 0
    buffer_load_dwordx4 v83, s[28:31], 0 offen lds
    s_add_u32 m0, s56, 0x20c00
    s_nop 0
    buffer_load_dwordx4 v111, s[28:31], 0 offen lds
    s_add_u32 s62, s100, 0x60000
    s_sub_u32 s101, s62, 0xc0000
    s_cselect_b32 s62, s62, s101
    s_add_u32 s62, s62, s94
    s_add_u32 s62, s62, 0x10000
    s_add_u32 m0, s56, 0xc000
    s_nop 0
    buffer_load_dwordx4 v6, s[32:35], s62 offen lds
    s_add_u32 m0, s56, 0xc400
    s_nop 0
    buffer_load_dwordx4 v7, s[32:35], s62 offen lds
    s_add_u32 m0, s56, 0xc800
    s_nop 0
    buffer_load_dwordx4 v8, s[32:35], s62 offen lds
    s_add_u32 m0, s56, 0xcc00
    s_nop 0
    buffer_load_dwordx4 v9, s[32:35], s62 offen lds
    s_waitcnt vmcnt(16)
    s_barrier
    s_add_u32 s62, s100, 0x60000
    s_sub_u32 s101, s62, 0xc0000
    s_cselect_b32 s62, s62, s101
    s_add_u32 s62, s62, s94
    s_add_u32 s62, s62, 0x18000
    s_add_u32 m0, s56, 0x0
    s_nop 0
    buffer_load_dwordx4 v6, s[32:35], s62 offen lds
    s_add_u32 m0, s56, 0x400
    s_nop 0
    buffer_load_dwordx4 v7, s[32:35], s62 offen lds
    s_add_u32 m0, s56, 0x800
    s_nop 0
    buffer_load_dwordx4 v8, s[32:35], s62 offen lds
    s_add_u32 m0, s56, 0xc00
    s_nop 0
    buffer_load_dwordx4 v9, s[32:35], s62 offen lds
    s_add_u32 m0, s56, 0x24000
    s_nop 0
    buffer_load_dwordx4 v28, s[28:31], 0 offen lds
    s_add_u32 m0, s56, 0x24400
    s_nop 0
    buffer_load_dwordx4 v56, s[28:31], 0 offen lds
    s_add_u32 m0, s56, 0x24800
    s_nop 0
    buffer_load_dwordx4 v84, s[28:31], 0 offen lds
    s_add_u32 m0, s56, 0x24c00
    s_nop 0
    buffer_load_dwordx4 v112, s[28:31], 0 offen lds
    s_waitcnt vmcnt(20)
    s_barrier
    s_add_u32 m0, s56, 0x10000
    s_nop 0
    buffer_load_dwordx4 v29, s[28:31], 0 offen lds
    s_add_u32 m0, s56, 0x10400
    s_nop 0
    buffer_load_dwordx4 v57, s[28:31], 0 offen lds
    s_add_u32 m0, s56, 0x10800
    s_nop 0
    buffer_load_dwordx4 v85, s[28:31], 0 offen lds
    s_add_u32 m0, s56, 0x10c00
    s_nop 0
    buffer_load_dwordx4 v113, s[28:31], 0 offen lds
    s_add_u32 s62, s100, 0x80000
    s_sub_u32 s101, s62, 0xc0000
    s_cselect_b32 s62, s62, s101
    s_add_u32 s62, s62, s94
    s_add_u32 m0, s56, 0x4000
    s_nop 0
    buffer_load_dwordx4 v6, s[32:35], s62 offen lds
    s_add_u32 m0, s56, 0x4400
    s_nop 0
    buffer_load_dwordx4 v7, s[32:35], s62 offen lds
    s_add_u32 m0, s56, 0x4800
    s_nop 0
    buffer_load_dwordx4 v8, s[32:35], s62 offen lds
    s_add_u32 m0, s56, 0x4c00
    s_nop 0
    buffer_load_dwordx4 v9, s[32:35], s62 offen lds
    s_waitcnt vmcnt(16)
    s_barrier
    s_add_u32 s62, s100, 0x80000
    s_sub_u32 s101, s62, 0xc0000
    s_cselect_b32 s62, s62, s101
    s_add_u32 s62, s62, s94
    s_add_u32 s62, s62, 0x8000
    s_add_u32 m0, s56, 0x8000
    s_nop 0
    buffer_load_dwordx4 v6, s[32:35], s62 offen lds
    s_add_u32 m0, s56, 0x8400
    s_nop 0
    buffer_load_dwordx4 v7, s[32:35], s62 offen lds
    s_add_u32 m0, s56, 0x8800
    s_nop 0
    buffer_load_dwordx4 v8, s[32:35], s62 offen lds
    s_add_u32 m0, s56, 0x8c00
    s_nop 0
    buffer_load_dwordx4 v9, s[32:35], s62 offen lds
    s_add_u32 m0, s56, 0x14000
    s_nop 0
    buffer_load_dwordx4 v30, s[28:31], 0 offen lds
    s_add_u32 m0, s56, 0x14400
    s_nop 0
    buffer_load_dwordx4 v58, s[28:31], 0 offen lds
    s_add_u32 m0, s56, 0x14800
    s_nop 0
    buffer_load_dwordx4 v86, s[28:31], 0 offen lds
    s_add_u32 m0, s56, 0x14c00
    s_nop 0
    buffer_load_dwordx4 v114, s[28:31], 0 offen lds
    s_waitcnt vmcnt(20)
    s_barrier
    s_add_u32 m0, s56, 0x18000
    s_nop 0
    buffer_load_dwordx4 v31, s[28:31], 0 offen lds
    s_add_u32 m0, s56, 0x18400
    s_nop 0
    buffer_load_dwordx4 v59, s[28:31], 0 offen lds
    s_add_u32 m0, s56, 0x18800
    s_nop 0
    buffer_load_dwordx4 v87, s[28:31], 0 offen lds
    s_add_u32 m0, s56, 0x18c00
    s_nop 0
    buffer_load_dwordx4 v115, s[28:31], 0 offen lds
    s_add_u32 s62, s100, 0x80000
    s_sub_u32 s101, s62, 0xc0000
    s_cselect_b32 s62, s62, s101
    s_add_u32 s62, s62, s94
    s_add_u32 s62, s62, 0x10000
    s_add_u32 m0, s56, 0xc000
    s_nop 0
    buffer_load_dwordx4 v6, s[32:35], s62 offen lds
    s_add_u32 m0, s56, 0xc400
    s_nop 0
    buffer_load_dwordx4 v7, s[32:35], s62 offen lds
    s_add_u32 m0, s56, 0xc800
    s_nop 0
    buffer_load_dwordx4 v8, s[32:35], s62 offen lds
    s_add_u32 m0, s56, 0xcc00
    s_nop 0
    buffer_load_dwordx4 v9, s[32:35], s62 offen lds
    s_waitcnt vmcnt(16)
    s_barrier
    s_add_u32 s62, s100, 0x80000
    s_sub_u32 s101, s62, 0xc0000
    s_cselect_b32 s62, s62, s101
    s_add_u32 s62, s62, s94
    s_add_u32 s62, s62, 0x18000
    s_add_u32 m0, s56, 0x0
    s_nop 0
    buffer_load_dwordx4 v6, s[32:35], s62 offen lds
    s_add_u32 m0, s56, 0x400
    s_nop 0
    buffer_load_dwordx4 v7, s[32:35], s62 offen lds
    s_add_u32 m0, s56, 0x800
    s_nop 0
    buffer_load_dwordx4 v8, s[32:35], s62 offen lds
    s_add_u32 m0, s56, 0xc00
    s_nop 0
    buffer_load_dwordx4 v9, s[32:35], s62 offen lds
    s_add_u32 m0, s56, 0x1c000
    s_nop 0
    buffer_load_dwordx4 v32, s[28:31], 0 offen lds
    s_add_u32 m0, s56, 0x1c400
    s_nop 0
    buffer_load_dwordx4 v60, s[28:31], 0 offen lds
    s_add_u32 m0, s56, 0x1c800
    s_nop 0
    buffer_load_dwordx4 v88, s[28:31], 0 offen lds
    s_add_u32 m0, s56, 0x1cc00
    s_nop 0
    buffer_load_dwordx4 v116, s[28:31], 0 offen lds
    s_waitcnt vmcnt(20)
    s_barrier
    s_add_u32 m0, s56, 0x20000
    s_nop 0
    buffer_load_dwordx4 v33, s[28:31], 0 offen lds
    s_add_u32 m0, s56, 0x20400
    s_nop 0
    buffer_load_dwordx4 v61, s[28:31], 0 offen lds
    s_add_u32 m0, s56, 0x20800
    s_nop 0
    buffer_load_dwordx4 v89, s[28:31], 0 offen lds
    s_add_u32 m0, s56, 0x20c00
    s_nop 0
    buffer_load_dwordx4 v117, s[28:31], 0 offen lds
    s_add_u32 s62, s100, 0xa0000
    s_sub_u32 s101, s62, 0xc0000
    s_cselect_b32 s62, s62, s101
    s_add_u32 s62, s62, s94
    s_add_u32 m0, s56, 0x4000
    s_nop 0
    buffer_load_dwordx4 v6, s[32:35], s62 offen lds
    s_add_u32 m0, s56, 0x4400
    s_nop 0
    buffer_load_dwordx4 v7, s[32:35], s62 offen lds
    s_add_u32 m0, s56, 0x4800
    s_nop 0
    buffer_load_dwordx4 v8, s[32:35], s62 offen lds
    s_add_u32 m0, s56, 0x4c00
    s_nop 0
    buffer_load_dwordx4 v9, s[32:35], s62 offen lds
    s_waitcnt vmcnt(16)
    s_barrier
    s_add_u32 s62, s100, 0xa0000
    s_sub_u32 s101, s62, 0xc0000
    s_cselect_b32 s62, s62, s101
    s_add_u32 s62, s62, s94
    s_add_u32 s62, s62, 0x8000
    s_add_u32 m0, s56, 0x8000
    s_nop 0
    buffer_load_dwordx4 v6, s[32:35], s62 offen lds
    s_add_u32 m0, s56, 0x8400
    s_nop 0
    buffer_load_dwordx4 v7, s[32:35], s62 offen lds
    s_add_u32 m0, s56, 0x8800
    s_nop 0
    buffer_load_dwordx4 v8, s[32:35], s62 offen lds
    s_add_u32 m0, s56, 0x8c00
    s_nop 0
    buffer_load_dwordx4 v9, s[32:35], s62 offen lds
    s_add_u32 m0, s56, 0x24000
    s_nop 0
    buffer_load_dwordx4 v34, s[28:31], 0 offen lds
    s_add_u32 m0, s56, 0x24400
    s_nop 0
    buffer_load_dwordx4 v62, s[28:31], 0 offen lds
    s_add_u32 m0, s56, 0x24800
    s_nop 0
    buffer_load_dwordx4 v90, s[28:31], 0 offen lds
    s_add_u32 m0, s56, 0x24c00
    s_nop 0
    buffer_load_dwordx4 v118, s[28:31], 0 offen lds
    s_waitcnt vmcnt(20)
    s_barrier
    s_add_u32 s62, s100, 0xa0000
    s_sub_u32 s101, s62, 0xc0000
    s_cselect_b32 s62, s62, s101
    s_add_u32 s62, s62, s94
    s_add_u32 s62, s62, 0x10000
    s_add_u32 m0, s56, 0xc000
    s_nop 0
    buffer_load_dwordx4 v6, s[32:35], s62 offen lds
    s_add_u32 m0, s56, 0xc400
    s_nop 0
    buffer_load_dwordx4 v7, s[32:35], s62 offen lds
    s_add_u32 m0, s56, 0xc800
    s_nop 0
    buffer_load_dwordx4 v8, s[32:35], s62 offen lds
    s_add_u32 m0, s56, 0xcc00
    s_nop 0
    buffer_load_dwordx4 v9, s[32:35], s62 offen lds
    s_add_u32 m0, s56, 0x10000
    s_nop 0
    buffer_load_dwordx4 v35, s[28:31], 0 offen lds
    s_add_u32 m0, s56, 0x10400
    s_nop 0
    buffer_load_dwordx4 v63, s[28:31], 0 offen lds
    s_add_u32 m0, s56, 0x10800
    s_nop 0
    buffer_load_dwordx4 v91, s[28:31], 0 offen lds
    s_add_u32 m0, s56, 0x10c00
    s_nop 0
    buffer_load_dwordx4 v119, s[28:31], 0 offen lds
    s_waitcnt vmcnt(16)
    s_barrier
    s_add_u32 s62, s100, 0xa0000
    s_sub_u32 s101, s62, 0xc0000
    s_cselect_b32 s62, s62, s101
    s_add_u32 s62, s62, s94
    s_add_u32 s62, s62, 0x18000
    s_add_u32 m0, s56, 0x0
    s_nop 0
    buffer_load_dwordx4 v6, s[32:35], s62 offen lds
    s_add_u32 m0, s56, 0x400
    s_nop 0
    buffer_load_dwordx4 v7, s[32:35], s62 offen lds
    s_add_u32 m0, s56, 0x800
    s_nop 0
    buffer_load_dwordx4 v8, s[32:35], s62 offen lds
    s_add_u32 m0, s56, 0xc00
    s_nop 0
    buffer_load_dwordx4 v9, s[32:35], s62 offen lds
    s_waitcnt vmcnt(16)
    s_barrier
    s_mov_b32 s36, s16
    s_and_b32 s37, s17, 0xffff
    s_mov_b32 s38, 0x200
    s_mov_b32 s39, 0x00020000
    s_mov_b32 s96, s18
    s_and_b32 s97, s19, 0xffff
    s_mov_b32 s98, 0x200
    s_mov_b32 s99, 0x00020000
    s_lshl_b32 s59, s55, 6
    v_lshrrev_b32 v2, 4, v1
    v_lshlrev_b32 v2, 3, v2
    buffer_load_dwordx2 v[124:125], v2, s[36:39], s59 offen offset:0
    buffer_load_dwordx2 v[132:133], v2, s[96:99], s59 offen offset:0
    buffer_load_dwordx2 v[126:127], v2, s[36:39], s59 offen offset:32
    buffer_load_dwordx2 v[134:135], v2, s[96:99], s59 offen offset:32
    buffer_load_dwordx2 v[128:129], v2, s[36:39], s59 offen offset:256
    buffer_load_dwordx2 v[136:137], v2, s[96:99], s59 offen offset:256
    buffer_load_dwordx2 v[130:131], v2, s[36:39], s59 offen offset:288
    buffer_load_dwordx2 v[138:139], v2, s[96:99], s59 offen offset:288
    s_nop 0
    s_mov_b32 s36, s8
    s_and_b32 s37, s9, 0xffff
    s_mov_b32 s38, 0x1a040
    s_mov_b32 s39, 0x00020000
    s_mov_b32 s96, s10
    s_and_b32 s97, s11, 0xffff
    s_mov_b32 s98, 0x40
    s_mov_b32 s99, 0x00020000
    v_and_b32 v3, 15, v1
    s_lshl_b32 s59, s63, 4
    v_add_u32 v3, s59, v3
    v_mul_u32_u24 v3, 26, v3
    v_lshrrev_b32 v2, 2, v2
    v_add_u32 v3, v3, v2
    buffer_load_ushort v140, v3, s[36:39], 0 offen offset:0
    buffer_load_ushort v144, v2, s[96:99], 0 offen offset:0
    buffer_load_ushort v141, v3, s[36:39], 0 offen offset:8
    buffer_load_ushort v145, v2, s[96:99], 0 offen offset:8
    buffer_load_ushort v142, v3, s[36:39], 0 offen offset:16
    buffer_load_ushort v146, v2, s[96:99], 0 offen offset:16
    v_mov_b32 v143, 0
    v_mov_b32 v147, 0
    s_mov_b64 exec, 0xffff
    buffer_load_ushort v143, v3, s[36:39], 0 offen offset:24
    buffer_load_ushort v147, v2, s[96:99], 0 offen offset:24
    s_mov_b64 exec, -1
    s_nop 0
    s_mov_b32 s36, s12
    s_and_b32 s37, s13, 0xffff
    s_mov_b32 s38, 0x40
    s_mov_b32 s39, 0x00020000
    s_mov_b32 s96, s20
    s_and_b32 s97, s21, 0xffff
    s_mov_b32 s98, 0x40
    s_mov_b32 s99, 0x00020000
    v_mov_b32 v4, 0
    buffer_load_ushort v148, v4, s[36:39], 0 offen
    buffer_load_ushort v149, v4, s[96:99], 0 offen
    s_waitcnt vmcnt(26)
    s_barrier
    s_waitcnt vmcnt(18)
    s_barrier
    s_barrier
    s_branch L_varj
L_var3:
    s_add_u32 m0, s56, 0x14000
    s_nop 0
    buffer_load_dwordx4 v13, s[28:31], 0 offen lds
    s_add_u32 m0, s56, 0x14400
    s_nop 0
    buffer_load_dwordx4 v41, s[28:31], 0 offen lds
    s_add_u32 m0, s56, 0x14800
    s_nop 0
    buffer_load_dwordx4 v69, s[28:31], 0 offen lds
    s_add_u32 m0, s56, 0x14c00
    s_nop 0
    buffer_load_dwordx4 v97, s[28:31], 0 offen lds
    s_waitcnt vmcnt(4)
    s_barrier
    s_add_u32 s62, s100, 0x0
    s_sub_u32 s101, s62, 0xc0000
    s_cselect_b32 s62, s62, s101
    s_add_u32 s62, s62, s94
    s_add_u32 s62, s62, 0x8000
    s_add_u32 m0, s56, 0x4000
    s_nop 0
    buffer_load_dwordx4 v6, s[32:35], s62 offen lds
    s_add_u32 m0, s56, 0x4400
    s_nop 0
    buffer_load_dwordx4 v7, s[32:35], s62 offen lds
    s_add_u32 m0, s56, 0x4800
    s_nop 0
    buffer_load_dwordx4 v8, s[32:35], s62 offen lds
    s_add_u32 m0, s56, 0x4c00
    s_nop 0
    buffer_load_dwordx4 v9, s[32:35], s62 offen lds
    s_add_u32 m0, s56, 0x18000
    s_nop 0
    buffer_load_dwordx4 v12, s[28:31], 0 offen lds
    s_add_u32 m0, s56, 0x18400
    s_nop 0
    buffer_load_dwordx4 v40, s[28:31], 0 offen lds
    s_add_u32 m0, s56, 0x18800
    s_nop 0
    buffer_load_dwordx4 v68, s[28:31], 0 offen lds
    s_add_u32 m0, s56, 0x18c00
    s_nop 0
    buffer_load_dwordx4 v96, s[28:31], 0 offen lds
    s_add_u32 s62, s100, 0x0
    s_sub_u32 s101, s62, 0xc0000
    s_cselect_b32 s62, s62, s101
    s_add_u32 s62, s62, s94
    s_add_u32 m0, s56, 0x8000
    s_nop 0
    buffer_load_dwordx4 v6, s[32:35], s62 offen lds
    s_add_u32 m0, s56, 0x8400
    s_nop 0
    buffer_load_dwordx4 v7, s[32:35], s62 offen lds
    s_add_u32 m0, s56, 0x8800
    s_nop 0
    buffer_load_dwordx4 v8, s[32:35], s62 offen lds
    s_add_u32 m0, s56, 0x8c00
    s_nop 0
    buffer_load_dwordx4 v9, s[32:35], s62 offen lds
    s_waitcnt vmcnt(8)
    s_barrier
    s_add_u32 m0, s56, 0x1c000
    s_nop 0
    buffer_load_dwordx4 v16, s[28:31], 0 offen lds
    s_add_u32 m0, s56, 0x1c400
    s_nop 0
    buffer_load_dwordx4 v44, s[28:31], 0 offen lds
    s_add_u32 m0, s56, 0x1c800
    s_nop 0
    buffer_load_dwordx4 v72, s[28:31], 0 offen lds
    s_add_u32 m0, s56, 0x1cc00
    s_nop 0
    buffer_load_dwordx4 v100, s[28:31], 0 offen lds
    s_add_u32 m0, s56, 0x20000
    s_nop 0
    buffer_load_dwordx4 v17, s[28:31], 0 offen lds
    s_add_u32 m0, s56, 0x20400
    s_nop 0
    buffer_load_dwordx4 v45, s[28:31], 0 offen lds
    s_add_u32 m0, s56, 0x20800
    s_nop 0
    buffer_load_dwordx4 v73, s[28:31], 0 offen lds
    s_add_u32 m0, s56, 0x20c00
    s_nop 0
    buffer_load_dwordx4 v101, s[28:31], 0 offen lds
    s_add_u32 s62, s100, 0x20000
    s_sub_u32 s101, s62, 0xc0000
    s_cselect_b32 s62, s62, s101
    s_add_u32 s62, s62, s94
    s_add_u32 m0, s56, 0xc000
    s_nop 0
    buffer_load_dwordx4 v6, s[32:35], s62 offen lds
    s_add_u32 m0, s56, 0xc400
    s_nop 0
    buffer_load_dwordx4 v7, s[32:35], s62 offen lds
    s_add_u32 m0, s56, 0xc800
    s_nop 0
    buffer_load_dwordx4 v8, s[32:35], s62 offen lds
    s_add_u32 m0, s56, 0xcc00
    s_nop 0
    buffer_load_dwordx4 v9, s[32:35], s62 offen lds
    s_waitcnt vmcnt(12)
    s_barrier
    s_add_u32 s62, s100, 0x20000
    s_sub_u32 s101, s62, 0xc0000
    s_cselect_b32 s62, s62, s101
    s_add_u32 s62, s62, s94
    s_add_u32 s62, s62, 0x8000
    s_add_u32 m0, s56, 0x0
    s_nop 0
    buffer_load_dwordx4 v6, s[32:35], s62 offen lds
    s_add_u32 m0, s56, 0x400
    s_nop 0
    buffer_load_dwordx4 v7, s[32:35], s62 offen lds
    s_add_u32 m0, s56, 0x800
    s_nop 0
    buffer_load_dwordx4 v8, s[32:35], s62 offen lds
    s_add_u32 m0, s56, 0xc00
    s_nop 0
    buffer_load_dwordx4 v9, s[32:35], s62 offen lds
    s_add_u32 m0, s56, 0x24000
    s_nop 0
    buffer_load_dwordx4 v14, s[28:31], 0 offen lds
    s_add_u32 m0, s56, 0x24400
    s_nop 0
    buffer_load_dwordx4 v42, s[28:31], 0 offen lds
    s_add_u32 m0, s56, 0x24800
    s_nop 0
    buffer_load_dwordx4 v70, s[28:31], 0 offen lds
    s_add_u32 m0, s56, 0x24c00
    s_nop 0
    buffer_load_dwordx4 v98, s[28:31], 0 offen lds
    s_add_u32 m0, s56, 0x10000
    s_nop 0
    buffer_load_dwordx4 v15, s[28:31], 0 offen lds
    s_add_u32 m0, s56, 0x10400
    s_nop 0
    buffer_load_dwordx4 v43, s[28:31], 0 offen lds
    s_add_u32 m0, s56, 0x10800
    s_nop 0
    buffer_load_dwordx4 v71, s[28:31], 0 offen lds
    s_add_u32 m0, s56, 0x10c00
    s_nop 0
    buffer_load_dwordx4 v99, s[28:31], 0 offen lds
    s_waitcnt vmcnt(12)
    s_barrier
    s_add_u32 s62, s100, 0x0
    s_sub_u32 s101, s62, 0xc0000
    s_cselect_b32 s62, s62, s101
    s_add_u32 s62, s62, s94
    s_add_u32 s62, s62, 0x10000
    s_add_u32 m0, s56, 0x4000
    s_nop 0
    buffer_load_dwordx4 v6, s[32:35], s62 offen lds
    s_add_u32 m0, s56, 0x4400
    s_nop 0
    buffer_load_dwordx4 v7, s[32:35], s62 offen lds
    s_add_u32 m0, s56, 0x4800
    s_nop 0
    buffer_load_dwordx4 v8, s[32:35], s62 offen lds
    s_add_u32 m0, s56, 0x4c00
    s_nop 0
    buffer_load_dwordx4 v9, s[32:35], s62 offen lds
    s_add_u32 s62, s100, 0x0
    s_sub_u32 s101, s62, 0xc0000
    s_cselect_b32 s62, s62, s101
    s_add_u32 s62, s62, s94
    s_add_u32 s62, s62, 0x18000
    s_add_u32 m0, s56, 0x8000
    s_nop 0
    buffer_load_dwordx4 v6, s[32:35], s62 offen lds
    s_add_u32 m0, s56, 0x8400
    s_nop 0
    buffer_load_dwordx4 v7, s[32:35], s62 offen lds
    s_add_u32 m0, s56, 0x8800
    s_nop 0
    buffer_load_dwordx4 v8, s[32:35], s62 offen lds
    s_add_u32 m0, s56, 0x8c00
    s_nop 0
    buffer_load_dwordx4 v9, s[32:35], s62 offen lds
    s_add_u32 m0, s56, 0x14000
    s_nop 0
    buffer_load_dwordx4 v20, s[28:31], 0 offen lds
    s_add_u32 m0, s56, 0x14400
    s_nop 0
    buffer_load_dwordx4 v48, s[28:31], 0 offen lds
    s_add_u32 m0, s56, 0x14800
    s_nop 0
    buffer_load_dwordx4 v76, s[28:31], 0 offen lds
    s_add_u32 m0, s56, 0x14c00
    s_nop 0
    buffer_load_dwordx4 v104, s[28:31], 0 offen lds
    s_cmp_lg_u32 s55, 0
    s_cbranch_scc1 L_nordy3
    v_mov_b32 v2, s63
    s_mov_b64 exec, 1
    buffer_store_byte v152, v2, s[44:47], 0 offen sc1
    s_mov_b64 exec, -1
L_nordy3:
    s_waitcnt vmcnt(20)
    s_barrier
    s_add_u32 m0, s56, 0x18000
    s_nop 0
    buffer_load_dwordx4 v21, s[28:31], 0 offen lds
    s_add_u32 m0, s56, 0x18400
    s_nop 0
    buffer_load_dwordx4 v49, s[28:31], 0 offen lds
    s_add_u32 m0, s56, 0x18800
    s_nop 0
    buffer_load_dwordx4 v77, s[28:31], 0 offen lds
    s_add_u32 m0, s56, 0x18c00
    s_nop 0
    buffer_load_dwordx4 v105, s[28:31], 0 offen lds
    s_add_u32 s62, s100, 0x40000
    s_sub_u32 s101, s62, 0xc0000
    s_cselect_b32 s62, s62, s101
    s_add_u32 s62, s62, s94
    s_add_u32 m0, s56, 0xc000
    s_nop 0
    buffer_load_dwordx4 v6, s[32:35], s62 offen lds
    s_add_u32 m0, s56, 0xc400
    s_nop 0
    buffer_load_dwordx4 v7, s[32:35], s62 offen lds
    s_add_u32 m0, s56, 0xc800
    s_nop 0
    buffer_load_dwordx4 v8, s[32:35], s62 offen lds
    s_add_u32 m0, s56, 0xcc00
    s_nop 0
    buffer_load_dwordx4 v9, s[32:35], s62 offen lds
    s_waitcnt vmcnt(16)
    s_barrier
    s_add_u32 s62, s100, 0x40000
    s_sub_u32 s101, s62, 0xc0000
    s_cselect_b32 s62, s62, s101
    s_add_u32 s62, s62, s94
    s_add_u32 s62, s62, 0x8000
    s_add_u32 m0, s56, 0x0
    s_nop 0
    buffer_load_dwordx4 v6, s[32:35], s62 offen lds
    s_add_u32 m0, s56, 0x400
    s_nop 0
    buffer_load_dwordx4 v7, s[32:35], s62 offen lds
    s_add_u32 m0, s56, 0x800
    s_nop 0
    buffer_load_dwordx4 v8, s[32:35], s62 offen lds
    s_add_u32 m0, s56, 0xc00
    s_nop 0
    buffer_load_dwordx4 v9, s[32:35], s62 offen lds
    s_add_u32 m0, s56, 0x1c000
    s_nop 0
    buffer_load_dwordx4 v18, s[28:31], 0 offen lds
    s_add_u32 m0, s56, 0x1c400
    s_nop 0
    buffer_load_dwordx4 v46, s[28:31], 0 offen lds
    s_add_u32 m0, s56, 0x1c800
    s_nop 0
    buffer_load_dwordx4 v74, s[28:31], 0 offen lds
    s_add_u32 m0, s56, 0x1cc00
    s_nop 0
    buffer_load_dwordx4 v102, s[28:31], 0 offen lds
    s_waitcnt vmcnt(20)
    s_barrier
    s_add_u32 m0, s56, 0x20000
    s_nop 0
    buffer_load_dwordx4 v19, s[28:31], 0 offen lds
    s_add_u32 m0, s56, 0x20400
    s_nop 0
    buffer_load_dwordx4 v47, s[28:31], 0 offen lds
    s_add_u32 m0, s56, 0x20800
    s_nop 0
    buffer_load_dwordx4 v75, s[28:31], 0 offen lds
    s_add_u32 m0, s56, 0x20c00
    s_nop 0
    buffer_load_dwordx4 v103, s[28:31], 0 offen lds
    s_add_u32 s62, s100, 0x20000
    s_sub_u32 s101, s62, 0xc0000
    s_cselect_b32 s62, s62, s101
    s_add_u32 s62, s62, s94
    s_add_u32 s62, s62, 0x10000
    s_add_u32 m0, s56, 0x4000
    s_nop 0
    buffer_load_dwordx4 v6, s[32:35], s62 offen lds
    s_add_u32 m0, s56, 0x4400
    s_nop 0
    buffer_load_dwordx4 v7, s[32:35], s62 offen lds
    s_add_u32 m0, s56, 0x4800
    s_nop 0
    buffer_load_dwordx4 v8, s[32:35], s62 offen lds
    s_add_u32 m0, s56, 0x4c00
    s_nop 0
    buffer_load_dwordx4 v9, s[32:35], s62 offen lds
    s_waitcnt vmcnt(16)
    s_barrier
    s_add_u32 s62, s100, 0x20000
    s_sub_u32 s101, s62, 0xc0000
    s_cselect_b32 s62, s62, s101
    s_add_u32 s62, s62, s94
    s_add_u32 s62, s62, 0x18000
    s_add_u32 m0, s56, 0x8000
    s_nop 0
    buffer_load_dwordx4 v6, s[32:35], s62 offen lds
    s_add_u32 m0, s56, 0x8400
    s_nop 0
    buffer_load_dwordx4 v7, s[32:35], s62 offen lds
    s_add_u32 m0, s56, 0x8800
    s_nop 0
    buffer_load_dwordx4 v8, s[32:35], s62 offen lds
    s_add_u32 m0, s56, 0x8c00
    s_nop 0
    buffer_load_dwordx4 v9, s[32:35], s62 offen lds
    s_add_u32 m0, s56, 0x24000
    s_nop 0
    buffer_load_dwordx4 v24, s[28:31], 0 offen lds
    s_add_u32 m0, s56, 0x24400
    s_nop 0
    buffer_load_dwordx4 v52, s[28:31], 0 offen lds
    s_add_u32 m0, s56, 0x24800
    s_nop 0
    buffer_load_dwordx4 v80, s[28:31], 0 offen lds
    s_add_u32 m0, s56, 0x24c00
    s_nop 0
    buffer_load_dwordx4 v108, s[28:31], 0 offen lds
    s_waitcnt vmcnt(20)
    s_barrier
    s_add_u32 m0, s56, 0x10000
    s_nop 0
    buffer_load_dwordx4 v25, s[28:31], 0 offen lds
    s_add_u32 m0, s56, 0x10400
    s_nop 0
    buffer_load_dwordx4 v53, s[28:31], 0 offen lds
    s_add_u32 m0, s56, 0x10800
    s_nop 0
    buffer_load_dwordx4 v81, s[28:31], 0 offen lds
    s_add_u32 m0, s56, 0x10c00
    s_nop 0
    buffer_load_dwordx4 v109, s[28:31], 0 offen lds
    s_add_u32 s62, s100, 0x60000
    s_sub_u32 s101, s62, 0xc0000
    s_cselect_b32 s62, s62, s101
    s_add_u32 s62, s62, s94
    s_add_u32 m0, s56, 0xc000
    s_nop 0
    buffer_load_dwordx4 v6, s[32:35], s62 offen lds
    s_add_u32 m0, s56, 0xc400
    s_nop 0
    buffer_load_dwordx4 v7, s[32:35], s62 offen lds
    s_add_u32 m0, s56, 0xc800
    s_nop 0
    buffer_load_dwordx4 v8, s[32:35], s62 offen lds
    s_add_u32 m0, s56, 0xcc00
    s_nop 0
    buffer_load_dwordx4 v9, s[32:35], s62 offen lds
    s_waitcnt vmcnt(16)
    s_barrier
    s_add_u32 s62, s100, 0x60000
    s_sub_u32 s101, s62, 0xc0000
    s_cselect_b32 s62, s62, s101
    s_add_u32 s62, s62, s94
    s_add_u32 s62, s62, 0x8000
    s_add_u32 m0, s56, 0x0
    s_nop 0
    buffer_load_dwordx4 v6, s[32:35], s62 offen lds
    s_add_u32 m0, s56, 0x400
    s_nop 0
    buffer_load_dwordx4 v7, s[32:35], s62 offen lds
    s_add_u32 m0, s56, 0x800
    s_nop 0
    buffer_load_dwordx4 v8, s[32:35], s62 offen lds
    s_add_u32 m0, s56, 0xc00
    s_nop 0
    buffer_load_dwordx4 v9, s[32:35], s62 offen lds
    s_add_u32 m0, s56, 0x14000
    s_nop 0
    buffer_load_dwordx4 v22, s[28:31], 0 offen lds
    s_add_u32 m0, s56, 0x14400
    s_nop 0
    buffer_load_dwordx4 v50, s[28:31], 0 offen lds
    s_add_u32 m0, s56, 0x14800
    s_nop 0
    buffer_load_dwordx4 v78, s[28:31], 0 offen lds
    s_add_u32 m0, s56, 0x14c00
    s_nop 0
    buffer_load_dwordx4 v106, s[28:31], 0 offen lds
    s_waitcnt vmcnt(20)
    s_barrier
    s_add_u32 m0, s56, 0x18000
    s_nop 0
    buffer_load_dwordx4 v23, s[28:31], 0 offen lds
    s_add_u32 m0, s56, 0x18400
    s_nop 0
    buffer_load_dwordx4 v51, s[28:31], 0 offen lds
    s_add_u32 m0, s56, 0x18800
    s_nop 0
    buffer_load_dwordx4 v79, s[28:31], 0 offen lds
    s_add_u32 m0, s56, 0x18c00
    s_nop 0
    buffer_load_dwordx4 v107, s[28:31], 0 offen lds
    s_add_u32 s62, s100, 0x40000
    s_sub_u32 s101, s62, 0xc0000
    s_cselect_b32 s62, s62, s101
    s_add_u32 s62, s62, s94
    s_add_u32 s62, s62, 0x10000
    s_add_u32 m0, s56, 0x4000
    s_nop 0
    buffer_load_dwordx4 v6, s[32:35], s62 offen lds
    s_add_u32 m0, s56, 0x4400
    s_nop 0
    buffer_load_dwordx4 v7, s[32:35], s62 offen lds
    s_add_u32 m0, s56, 0x4800
    s_nop 0
    buffer_load_dwordx4 v8, s[32:35], s62 offen lds
    s_add_u32 m0, s56, 0x4c00
    s_nop 0
    buffer_load_dwordx4 v9, s[32:35], s62 offen lds
    s_waitcnt vmcnt(16)
    s_barrier
    s_add_u32 s62, s100, 0x40000
    s_sub_u32 s101, s62, 0xc0000
    s_cselect_b32 s62, s62, s101
    s_add_u32 s62, s62, s94
    s_add_u32 s62, s62, 0x18000
    s_add_u32 m0, s56, 0x8000
    s_nop 0
    buffer_load_dwordx4 v6, s[32:35], s62 offen lds
    s_add_u32 m0, s56, 0x8400
    s_nop 0
    buffer_load_dwordx4 v7, s[32:35], s62 offen lds
    s_add_u32 m0, s56, 0x8800
    s_nop 0
    buffer_load_dwordx4 v8, s[32:35], s62 offen lds
    s_add_u32 m0, s56, 0x8c00
    s_nop 0
    buffer_load_dwordx4 v9, s[32:35], s62 offen lds
    s_add_u32 m0, s56, 0x1c000
    s_nop 0
    buffer_load_dwordx4 v28, s[28:31], 0 offen lds
    s_add_u32 m0, s56, 0x1c400
    s_nop 0
    buffer_load_dwordx4 v56, s[28:31], 0 offen lds
    s_add_u32 m0, s56, 0x1c800
    s_nop 0
    buffer_load_dwordx4 v84, s[28:31], 0 offen lds
    s_add_u32 m0, s56, 0x1cc00
    s_nop 0
    buffer_load_dwordx4 v112, s[28:31], 0 offen lds
    s_waitcnt vmcnt(20)
    s_barrier
    s_add_u32 m0, s56, 0x20000
    s_nop 0
    buffer_load_dwordx4 v29, s[28:31], 0 offen lds
    s_add_u32 m0, s56, 0x20400
    s_nop 0
    buffer_load_dwordx4 v57, s[28:31], 0 offen lds
    s_add_u32 m0, s56, 0x20800
    s_nop 0
    buffer_load_dwordx4 v85, s[28:31], 0 offen lds
    s_add_u32 m0, s56, 0x20c00
    s_nop 0
    buffer_load_dwordx4 v113, s[28:31], 0 offen lds
    s_add_u32 s62, s100, 0x80000
    s_sub_u32 s101, s62, 0xc0000
    s_cselect_b32 s62, s62, s101
    s_add_u32 s62, s62, s94
    s_add_u32 m0, s56, 0xc000
    s_nop 0
    buffer_load_dwordx4 v6, s[32:35], s62 offen lds
    s_add_u32 m0, s56, 0xc400
    s_nop 0
    buffer_load_dwordx4 v7, s[32:35], s62 offen lds
    s_add_u32 m0, s56, 0xc800
    s_nop 0
    buffer_load_dwordx4 v8, s[32:35], s62 offen lds
    s_add_u32 m0, s56, 0xcc00
    s_nop 0
    buffer_load_dwordx4 v9, s[32:35], s62 offen lds
    s_waitcnt vmcnt(16)
    s_barrier
    s_add_u32 s62, s100, 0x80000
    s_sub_u32 s101, s62, 0xc0000
    s_cselect_b32 s62, s62, s101
    s_add_u32 s62, s62, s94
    s_add_u32 s62, s62, 0x8000
    s_add_u32 m0, s56, 0x0
    s_nop 0
    buffer_load_dwordx4 v6, s[32:35], s62 offen lds
    s_add_u32 m0, s56, 0x400
    s_nop 0
    buffer_load_dwordx4 v7, s[32:35], s62 offen lds
    s_add_u32 m0, s56, 0x800
    s_nop 0
    buffer_load_dwordx4 v8, s[32:35], s62 offen lds
    s_add_u32 m0, s56, 0xc00
    s_nop 0
    buffer_load_dwordx4 v9, s[32:35], s62 offen lds
    s_add_u32 m0, s56, 0x24000
    s_nop 0
    buffer_load_dwordx4 v26, s[28:31], 0 offen lds
    s_add_u32 m0, s56, 0x24400
    s_nop 0
    buffer_load_dwordx4 v54, s[28:31], 0 offen lds
    s_add_u32 m0, s56, 0x24800
    s_nop 0
    buffer_load_dwordx4 v82, s[28:31], 0 offen lds
    s_add_u32 m0, s56, 0x24c00
    s_nop 0
    buffer_load_dwordx4 v110, s[28:31], 0 offen lds
    s_waitcnt vmcnt(20)
    s_barrier
    s_add_u32 m0, s56, 0x10000
    s_nop 0
    buffer_load_dwordx4 v27, s[28:31], 0 offen lds
    s_add_u32 m0, s56, 0x10400
    s_nop 0
    buffer_load_dwordx4 v55, s[28:31], 0 offen lds
    s_add_u32 m0, s56, 0x10800
    s_nop 0
    buffer_load_dwordx4 v83, s[28:31], 0 offen lds
    s_add_u32 m0, s56, 0x10c00
    s_nop 0
    buffer_load_dwordx4 v111, s[28:31], 0 offen lds
    s_add_u32 s62, s100, 0x60000
    s_sub_u32 s101, s62, 0xc0000
    s_cselect_b32 s62, s62, s101
    s_add_u32 s62, s62, s94
    s_add_u32 s62, s62, 0x10000
    s_add_u32 m0, s56, 0x4000
    s_nop 0
    buffer_load_dwordx4 v6, s[32:35], s62 offen lds
    s_add_u32 m0, s56, 0x4400
    s_nop 0
    buffer_load_dwordx4 v7, s[32:35], s62 offen lds
    s_add_u32 m0, s56, 0x4800
    s_nop 0
    buffer_load_dwordx4 v8, s[32:35], s62 offen lds
    s_add_u32 m0, s56, 0x4c00
    s_nop 0
    buffer_load_dwordx4 v9, s[32:35], s62 offen lds
    s_waitcnt vmcnt(16)
    s_barrier
    s_add_u32 s62, s100, 0x60000
    s_sub_u32 s101, s62, 0xc0000
    s_cselect_b32 s62, s62, s101
    s_add_u32 s62, s62, s94
    s_add_u32 s62, s62, 0x18000
    s_add_u32 m0, s56, 0x8000
    s_nop 0
    buffer_load_dwordx4 v6, s[32:35], s62 offen lds
    s_add_u32 m0, s56, 0x8400
    s_nop 0
    buffer_load_dwordx4 v7, s[32:35], s62 offen lds
    s_add_u32 m0, s56, 0x8800
    s_nop 0
    buffer_load_dwordx4 v8, s[32:35], s62 offen lds
    s_add_u32 m0, s56, 0x8c00
    s_nop 0
    buffer_load_dwordx4 v9, s[32:35], s62 offen lds
    s_add_u32 m0, s56, 0x14000
    s_nop 0
    buffer_load_dwordx4 v32, s[28:31], 0 offen lds
    s_add_u32 m0, s56, 0x14400
    s_nop 0
    buffer_load_dwordx4 v60, s[28:31], 0 offen lds
    s_add_u32 m0, s56, 0x14800
    s_nop 0
    buffer_load_dwordx4 v88, s[28:31], 0 offen lds
    s_add_u32 m0, s56, 0x14c00
    s_nop 0
    buffer_load_dwordx4 v116, s[28:31], 0 offen lds
    s_waitcnt vmcnt(20)
    s_barrier
    s_add_u32 m0, s56, 0x18000
    s_nop 0
    buffer_load_dwordx4 v33, s[28:31], 0 offen lds
    s_add_u32 m0, s56, 0x18400
    s_nop 0
    buffer_load_dwordx4 v61, s[28:31], 0 offen lds
    s_add_u32 m0, s56, 0x18800
    s_nop 0
    buffer_load_dwordx4 v89, s[28:31], 0 offen lds
    s_add_u32 m0, s56, 0x18c00
    s_nop 0
    buffer_load_dwordx4 v117, s[28:31], 0 offen lds
    s_add_u32 s62, s100, 0xa0000
    s_sub_u32 s101, s62, 0xc0000
    s_cselect_b32 s62, s62, s101
    s_add_u32 s62, s62, s94
    s_add_u32 m0, s56, 0xc000
    s_nop 0
    buffer_load_dwordx4 v6, s[32:35], s62 offen lds
    s_add_u32 m0, s56, 0xc400
    s_nop 0
    buffer_load_dwordx4 v7, s[32:35], s62 offen lds
    s_add_u32 m0, s56, 0xc800
    s_nop 0
    buffer_load_dwordx4 v8, s[32:35], s62 offen lds
    s_add_u32 m0, s56, 0xcc00
    s_nop 0
    buffer_load_dwordx4 v9, s[32:35], s62 offen lds
    s_waitcnt vmcnt(16)
    s_barrier
    s_add_u32 s62, s100, 0xa0000
    s_sub_u32 s101, s62, 0xc0000
    s_cselect_b32 s62, s62, s101
    s_add_u32 s62, s62, s94
    s_add_u32 s62, s62, 0x8000
    s_add_u32 m0, s56, 0x0
    s_nop 0
    buffer_load_dwordx4 v6, s[32:35], s62 offen lds
    s_add_u32 m0, s56, 0x400
    s_nop 0
    buffer_load_dwordx4 v7, s[32:35], s62 offen lds
    s_add_u32 m0, s56, 0x800
    s_nop 0
    buffer_load_dwordx4 v8, s[32:35], s62 offen lds
    s_add_u32 m0, s56, 0xc00
    s_nop 0
    buffer_load_dwordx4 v9, s[32:35], s62 offen lds
    s_add_u32 m0, s56, 0x1c000
    s_nop 0
    buffer_load_dwordx4 v30, s[28:31], 0 offen lds
    s_add_u32 m0, s56, 0x1c400
    s_nop 0
    buffer_load_dwordx4 v58, s[28:31], 0 offen lds
    s_add_u32 m0, s56, 0x1c800
    s_nop 0
    buffer_load_dwordx4 v86, s[28:31], 0 offen lds
    s_add_u32 m0, s56, 0x1cc00
    s_nop 0
    buffer_load_dwordx4 v114, s[28:31], 0 offen lds
    s_waitcnt vmcnt(20)
    s_barrier
    s_add_u32 m0, s56, 0x20000
    s_nop 0
    buffer_load_dwordx4 v31, s[28:31], 0 offen lds
    s_add_u32 m0, s56, 0x20400
    s_nop 0
    buffer_load_dwordx4 v59, s[28:31], 0 offen lds
    s_add_u32 m0, s56, 0x20800
    s_nop 0
    buffer_load_dwordx4 v87, s[28:31], 0 offen lds
    s_add_u32 m0, s56, 0x20c00
    s_nop 0
    buffer_load_dwordx4 v115, s[28:31], 0 offen lds
    s_add_u32 s62, s100, 0x80000
    s_sub_u32 s101, s62, 0xc0000
    s_cselect_b32 s62, s62, s101
    s_add_u32 s62, s62, s94
    s_add_u32 s62, s62, 0x10000
    s_add_u32 m0, s56, 0x4000
    s_nop 0
    buffer_load_dwordx4 v6, s[32:35], s62 offen lds
    s_add_u32 m0, s56, 0x4400
    s_nop 0
    buffer_load_dwordx4 v7, s[32:35], s62 offen lds
    s_add_u32 m0, s56, 0x4800
    s_nop 0
    buffer_load_dwordx4 v8, s[32:35], s62 offen lds
    s_add_u32 m0, s56, 0x4c00
    s_nop 0
    buffer_load_dwordx4 v9, s[32:35], s62 offen lds
    s_waitcnt vmcnt(16)
    s_barrier
    s_add_u32 s62, s100, 0x80000
    s_sub_u32 s101, s62, 0xc0000
    s_cselect_b32 s62, s62, s101
    s_add_u32 s62, s62, s94
    s_add_u32 s62, s62, 0x18000
    s_add_u32 m0, s56, 0x8000
    s_nop 0
    buffer_load_dwordx4 v6, s[32:35], s62 offen lds
    s_add_u32 m0, s56, 0x8400
    s_nop 0
    buffer_load_dwordx4 v7, s[32:35], s62 offen lds
    s_add_u32 m0, s56, 0x8800
    s_nop 0
    buffer_load_dwordx4 v8, s[32:35], s62 offen lds
    s_add_u32 m0, s56, 0x8c00
    s_nop 0
    buffer_load_dwordx4 v9, s[32:35], s62 offen lds
    s_add_u32 m0, s56, 0x24000
    s_nop 0
    buffer_load_dwordx4 v35, s[28:31], 0 offen lds
    s_add_u32 m0, s56, 0x24400
    s_nop 0
    buffer_load_dwordx4 v63, s[28:31], 0 offen lds
    s_add_u32 m0, s56, 0x24800
    s_nop 0
    buffer_load_dwordx4 v91, s[28:31], 0 offen lds
    s_add_u32 m0, s56, 0x24c00
    s_nop 0
    buffer_load_dwordx4 v119, s[28:31], 0 offen lds
    s_waitcnt vmcnt(20)
    s_barrier
    s_add_u32 s62, s100, 0xa0000
    s_sub_u32 s101, s62, 0xc0000
    s_cselect_b32 s62, s62, s101
    s_add_u32 s62, s62, s94
    s_add_u32 s62, s62, 0x18000
    s_add_u32 m0, s56, 0xc000
    s_nop 0
    buffer_load_dwordx4 v6, s[32:35], s62 offen lds
    s_add_u32 m0, s56, 0xc400
    s_nop 0
    buffer_load_dwordx4 v7, s[32:35], s62 offen lds
    s_add_u32 m0, s56, 0xc800
    s_nop 0
    buffer_load_dwordx4 v8, s[32:35], s62 offen lds
    s_add_u32 m0, s56, 0xcc00
    s_nop 0
    buffer_load_dwordx4 v9, s[32:35], s62 offen lds
    s_add_u32 m0, s56, 0x10000
    s_nop 0
    buffer_load_dwordx4 v34, s[28:31], 0 offen lds
    s_add_u32 m0, s56, 0x10400
    s_nop 0
    buffer_load_dwordx4 v62, s[28:31], 0 offen lds
    s_add_u32 m0, s56, 0x10800
    s_nop 0
    buffer_load_dwordx4 v90, s[28:31], 0 offen lds
    s_add_u32 m0, s56, 0x10c00
    s_nop 0
    buffer_load_dwordx4 v118, s[28:31], 0 offen lds
    s_waitcnt vmcnt(16)
    s_barrier
    s_add_u32 s62, s100, 0xa0000
    s_sub_u32 s101, s62, 0xc0000
    s_cselect_b32 s62, s62, s101
    s_add_u32 s62, s62, s94
    s_add_u32 s62, s62, 0x10000
    s_add_u32 m0, s56, 0x0
    s_nop 0
    buffer_load_dwordx4 v6, s[32:35], s62 offen lds
    s_add_u32 m0, s56, 0x400
    s_nop 0
    buffer_load_dwordx4 v7, s[32:35], s62 offen lds
    s_add_u32 m0, s56, 0x800
    s_nop 0
    buffer_load_dwordx4 v8, s[32:35], s62 offen lds
    s_add_u32 m0, s56, 0xc00
    s_nop 0
    buffer_load_dwordx4 v9, s[32:35], s62 offen lds
    s_waitcnt vmcnt(16)
    s_barrier
    s_mov_b32 s36, s16
    s_and_b32 s37, s17, 0xffff
    s_mov_b32 s38, 0x200
    s_mov_b32 s39, 0x00020000
    s_mov_b32 s96, s18
    s_and_b32 s97, s19, 0xffff
    s_mov_b32 s98, 0x200
    s_mov_b32 s99, 0x00020000
    s_lshl_b32 s59, s55, 6
    v_lshrrev_b32 v2, 4, v1
    v_lshlrev_b32 v2, 3, v2
    buffer_load_dwordx2 v[124:125], v2, s[36:39], s59 offen offset:0
    buffer_load_dwordx2 v[132:133], v2, s[96:99], s59 offen offset:0
    buffer_load_dwordx2 v[126:127], v2, s[36:39], s59 offen offset:32
    buffer_load_dwordx2 v[134:135], v2, s[96:99], s59 offen offset:32
    buffer_load_dwordx2 v[128:129], v2, s[36:39], s59 offen offset:256
    buffer_load_dwordx2 v[136:137], v2, s[96:99], s59 offen offset:256
    buffer_load_dwordx2 v[130:131], v2, s[36:39], s59 offen offset:288
    buffer_load_dwordx2 v[138:139], v2, s[96:99], s59 offen offset:288
    s_nop 0
    s_mov_b32 s36, s8
    s_and_b32 s37, s9, 0xffff
    s_mov_b32 s38, 0x1a040
    s_mov_b32 s39, 0x00020000
    s_mov_b32 s96, s10
    s_and_b32 s97, s11, 0xffff
    s_mov_b32 s98, 0x40
    s_mov_b32 s99, 0x00020000
    v_and_b32 v3, 15, v1
    s_lshl_b32 s59, s63, 4
    v_add_u32 v3, s59, v3
    v_mul_u32_u24 v3, 26, v3
    v_lshrrev_b32 v2, 2, v2
    v_add_u32 v3, v3, v2
    buffer_load_ushort v140, v3, s[36:39], 0 offen offset:0
    buffer_load_ushort v144, v2, s[96:99], 0 offen offset:0
    buffer_load_ushort v141, v3, s[36:39], 0 offen offset:8
    buffer_load_ushort v145, v2, s[96:99], 0 offen offset:8
    buffer_load_ushort v142, v3, s[36:39], 0 offen offset:16
    buffer_load_ushort v146, v2, s[96:99], 0 offen offset:16
    v_mov_b32 v143, 0
    v_mov_b32 v147, 0
    s_mov_b64 exec, 0xffff
    buffer_load_ushort v143, v3, s[36:39], 0 offen offset:24
    buffer_load_ushort v147, v2, s[96:99], 0 offen offset:24
    s_mov_b64 exec, -1
    s_nop 0
    s_mov_b32 s36, s12
    s_and_b32 s37, s13, 0xffff
    s_mov_b32 s38, 0x40
    s_mov_b32 s39, 0x00020000
    s_mov_b32 s96, s20
    s_and_b32 s97, s21, 0xffff
    s_mov_b32 s98, 0x40
    s_mov_b32 s99, 0x00020000
    v_mov_b32 v4, 0
    buffer_load_ushort v148, v4, s[36:39], 0 offen
    buffer_load_ushort v149, v4, s[96:99], 0 offen
    s_waitcnt vmcnt(26)
    s_barrier
    s_waitcnt vmcnt(18)
    s_barrier
    s_barrier
L_varj:
    s_waitcnt vmcnt(0)
    v_lshlrev_b32 v140, 16, v140
    v_lshlrev_b32 v144, 16, v144
    v_lshlrev_b32 v141, 16, v141
    v_lshlrev_b32 v145, 16, v145
    v_lshlrev_b32 v142, 16, v142
    v_lshlrev_b32 v146, 16, v146
    v_lshlrev_b32 v143, 16, v143
    v_lshlrev_b32 v147, 16, v147
    v_mul_f32 v2, v140, v144
    v_fmac_f32 v2, v141, v145
    v_fmac_f32 v2, v142, v146
    v_fmac_f32 v2, v143, v147
    v_mov_b32 v3, v2
    s_nop 1
    v_permlane32_swap_b32 v2, v3
    s_nop 1
    v_add_f32 v2, v2, v3
    v_mov_b32 v3, v2
    s_nop 1
    v_permlane16_swap_b32 v2, v3
    s_nop 1
    v_add_f32 v2, v2, v3
    v_cvt_pk_bf16_f32 v2, v2, v2
    v_lshlrev_b32 v2, 16, v2
    v_lshlrev_b32 v148, 16, v148
    v_lshlrev_b32 v149, 16, v149
    v_add_f32 v2, v2, v148
    v_cvt_pk_bf16_f32 v2, v2, v2
    v_lshlrev_b32 v2, 16, v2
    v_lshlrev_b32 v12, 16, v124
    v_and_b32 v13, 0xffff0000, v124
    v_lshlrev_b32 v28, 16, v132
    v_and_b32 v29, 0xffff0000, v132
    v_lshlrev_b32 v14, 16, v125
    v_and_b32 v15, 0xffff0000, v125
    v_lshlrev_b32 v30, 16, v133
    v_and_b32 v31, 0xffff0000, v133
    v_lshlrev_b32 v16, 16, v126
    v_and_b32 v17, 0xffff0000, v126
    v_lshlrev_b32 v32, 16, v134
    v_and_b32 v33, 0xffff0000, v134
    v_lshlrev_b32 v18, 16, v127
    v_and_b32 v19, 0xffff0000, v127
    v_lshlrev_b32 v34, 16, v135
    v_and_b32 v35, 0xffff0000, v135
    v_lshlrev_b32 v20, 16, v128
    v_and_b32 v21, 0xffff0000, v128
    v_lshlrev_b32 v36, 16, v136
    v_and_b32 v37, 0xffff0000, v136
    v_lshlrev_b32 v22, 16, v129
    v_and_b32 v23, 0xffff0000, v129
    v_lshlrev_b32 v38, 16, v137
    v_and_b32 v39, 0xffff0000, v137
    v_lshlrev_b32 v24, 16, v130
    v_and_b32 v25, 0xffff0000, v130
    v_lshlrev_b32 v40, 16, v138
    v_and_b32 v41, 0xffff0000, v138
    v_lshlrev_b32 v26, 16, v131
    v_and_b32 v27, 0xffff0000, v131
    v_lshlrev_b32 v42, 16, v139
    v_and_b32 v43, 0xffff0000, v139
    v_mov_b32 v176, 0
    v_mov_b32 v177, 0
    v_mov_b32 v178, 0
    v_mov_b32 v179, 0
    v_mov_b32 v180, 0
    v_mov_b32 v181, 0
    v_mov_b32 v182, 0
    v_mov_b32 v183, 0
    v_mov_b32 v184, 0
    v_mov_b32 v185, 0
    v_mov_b32 v186, 0
    v_mov_b32 v187, 0
    v_mov_b32 v188, 0
    v_mov_b32 v189, 0
    v_mov_b32 v190, 0
    v_mov_b32 v191, 0
    v_mov_b32 v192, 0
    v_mov_b32 v193, 0
    v_mov_b32 v194, 0
    v_mov_b32 v195, 0
    v_mov_b32 v196, 0
    v_mov_b32 v197, 0
    v_mov_b32 v198, 0
    v_mov_b32 v199, 0
    v_mov_b32 v200, 0
    v_mov_b32 v201, 0
    v_mov_b32 v202, 0
    v_mov_b32 v203, 0
    v_mov_b32 v204, 0
    v_mov_b32 v205, 0
    v_mov_b32 v206, 0
    v_mov_b32 v207, 0
    v_mov_b32 v208, 0
    v_mov_b32 v209, 0
    v_mov_b32 v210, 0
    v_mov_b32 v211, 0
    v_mov_b32 v212, 0
    v_mov_b32 v213, 0
    v_mov_b32 v214, 0
    v_mov_b32 v215, 0
    v_mov_b32 v216, 0
    v_mov_b32 v217, 0
    v_mov_b32 v218, 0
    v_mov_b32 v219, 0
    v_mov_b32 v220, 0
    v_mov_b32 v221, 0
    v_mov_b32 v222, 0
    v_mov_b32 v223, 0
    v_mov_b32 v224, 0
    v_mov_b32 v225, 0
    v_mov_b32 v226, 0
    v_mov_b32 v227, 0
    v_mov_b32 v228, 0
    v_mov_b32 v229, 0
    v_mov_b32 v230, 0
    v_mov_b32 v231, 0
    v_mov_b32 v232, 0
    v_mov_b32 v233, 0
    v_mov_b32 v234, 0
    v_mov_b32 v235, 0
    v_mov_b32 v236, 0
    v_mov_b32 v237, 0
    v_mov_b32 v238, 0
    v_mov_b32 v239, 0
    s_mov_b32 s67, 0
    s_lshl_b32 s65, 1, s54
    s_lshl_b32 s60, s63, 3
    v_lshlrev_b32 v5, 2, v1
    v_add_u32 v5, 0x4400, v5
    v_mov_b32 v4, 0
    ds_write_b32 v5, v4
    s_mov_b32 m0, 0x4400
    s_waitcnt lgkmcnt(0)
    s_barrier
    v_lshlrev_b32 v3, 4, v1
    s_lshl_b32 s61, s55, 11
    v_add_u32 v3, s61, v3
    v_mov_b32 v156, 0
    v_mov_b32 v157, 0
    v_mov_b32 v158, 0
    v_mov_b32 v159, 0
    v_mov_b32 v160, 0
    v_mov_b32 v161, 0
    v_mov_b32 v162, 0
    v_mov_b32 v163, 0
    v_mov_b32 v164, 0
    v_mov_b32 v165, 0
    v_mov_b32 v166, 0
    v_mov_b32 v167, 0
    v_mov_b32 v168, 0
    v_mov_b32 v169, 0
    v_mov_b32 v170, 0
    v_mov_b32 v171, 0
    s_cmp_eq_u32 s68, 0
    s_cbranch_scc0 L_own1
    ds_read_b128 v[156:159], v3 offset:0
    ds_read_b128 v[160:163], v3 offset:1024
    s_branch L_ownj
L_own1:
    ds_read_b128 v[164:167], v3 offset:0
    ds_read_b128 v[168:171], v3 offset:1024
L_ownj:
    s_mov_b32 s92, 0x0c04000c
    s_mov_b32 s93, 0x0402010c
L_rxloop:
    ds_read_b32 v4, v5
    s_add_u32 s67, s67, 1
    s_cmp_gt_u32 s67, 0x20000
    s_cbranch_scc1 L_rxdone
    s_waitcnt vmcnt(30) lgkmcnt(0)
    v_cmp_ne_u32 vcc, 0, v4
    s_nop 1
    s_andn2_b32 s64, vcc_lo, s65
    s_cbranch_scc0 L_rxloop
    s_or_b32 s65, s65, s64
    s_bitcmp1_b32 s64, 0
    s_cbranch_scc0 L_rxs0
    s_add_u32 s61, s60, 0
    s_mul_i32 s61, s61, 6144
    buffer_load_dwordx3 v[176:178], v151, s[40:43], s61 offen offset:0 sc1
    buffer_load_dwordx3 v[180:182], v151, s[40:43], s61 offen offset:768 sc1
L_rxs0:
    s_bitcmp1_b32 s64, 1
    s_cbranch_scc0 L_rxs1
    s_add_u32 s61, s60, 1
    s_mul_i32 s61, s61, 6144
    buffer_load_dwordx3 v[184:186], v151, s[40:43], s61 offen offset:0 sc1
    buffer_load_dwordx3 v[188:190], v151, s[40:43], s61 offen offset:768 sc1
L_rxs1:
    s_bitcmp1_b32 s64, 2
    s_cbranch_scc0 L_rxs2
    s_add_u32 s61, s60, 2
    s_mul_i32 s61, s61, 6144
    buffer_load_dwordx3 v[192:194], v151, s[40:43], s61 offen offset:0 sc1
    buffer_load_dwordx3 v[196:198], v151, s[40:43], s61 offen offset:768 sc1
L_rxs2:
    s_bitcmp1_b32 s64, 3
    s_cbranch_scc0 L_rxs3
    s_add_u32 s61, s60, 3
    s_mul_i32 s61, s61, 6144
    buffer_load_dwordx3 v[200:202], v151, s[40:43], s61 offen offset:0 sc1
    buffer_load_dwordx3 v[204:206], v151, s[40:43], s61 offen offset:768 sc1
L_rxs3:
    s_bitcmp1_b32 s64, 4
    s_cbranch_scc0 L_rxs4
    s_add_u32 s61, s60, 4
    s_mul_i32 s61, s61, 6144
    buffer_load_dwordx3 v[208:210], v151, s[40:43], s61 offen offset:0 sc1
    buffer_load_dwordx3 v[212:214], v151, s[40:43], s61 offen offset:768 sc1
L_rxs4:
    s_bitcmp1_b32 s64, 5
    s_cbranch_scc0 L_rxs5
    s_add_u32 s61, s60, 5
    s_mul_i32 s61, s61, 6144
    buffer_load_dwordx3 v[216:218], v151, s[40:43], s61 offen offset:0 sc1
    buffer_load_dwordx3 v[220:222], v151, s[40:43], s61 offen offset:768 sc1
L_rxs5:
    s_bitcmp1_b32 s64, 6
    s_cbranch_scc0 L_rxs6
    s_add_u32 s61, s60, 6
    s_mul_i32 s61, s61, 6144
    buffer_load_dwordx3 v[224:226], v151, s[40:43], s61 offen offset:0 sc1
    buffer_load_dwordx3 v[228:230], v151, s[40:43], s61 offen offset:768 sc1
L_rxs6:
    s_bitcmp1_b32 s64, 7
    s_cbranch_scc0 L_rxs7
    s_add_u32 s61, s60, 7
    s_mul_i32 s61, s61, 6144
    buffer_load_dwordx3 v[232:234], v151, s[40:43], s61 offen offset:0 sc1
    buffer_load_dwordx3 v[236:238], v151, s[40:43], s61 offen offset:768 sc1
L_rxs7:
    s_cmp_lg_u32 s65, 0xff
    s_cbranch_scc1 L_rxloop
L_rxdone:
    s_waitcnt vmcnt(0) lgkmcnt(0)
    v_perm_b32 v179, v177, v176, s92
    v_perm_b32 v179, v178, v179, s93
    v_perm_b32 v183, v181, v180, s92
    v_perm_b32 v183, v182, v183, s93
    v_pk_add_f32 v[156:157], v[156:157], v[176:177]
    v_pk_add_f32 v[158:159], v[158:159], v[178:179]
    v_pk_add_f32 v[160:161], v[160:161], v[180:181]
    v_pk_add_f32 v[162:163], v[162:163], v[182:183]
    v_perm_b32 v187, v185, v184, s92
    v_perm_b32 v187, v186, v187, s93
    v_perm_b32 v191, v189, v188, s92
    v_perm_b32 v191, v190, v191, s93
    v_pk_add_f32 v[156:157], v[156:157], v[184:185]
    v_pk_add_f32 v[158:159], v[158:159], v[186:187]
    v_pk_add_f32 v[160:161], v[160:161], v[188:189]
    v_pk_add_f32 v[162:163], v[162:163], v[190:191]
    v_perm_b32 v195, v193, v192, s92
    v_perm_b32 v195, v194, v195, s93
    v_perm_b32 v199, v197, v196, s92
    v_perm_b32 v199, v198, v199, s93
    v_pk_add_f32 v[156:157], v[156:157], v[192:193]
    v_pk_add_f32 v[158:159], v[158:159], v[194:195]
    v_pk_add_f32 v[160:161], v[160:161], v[196:197]
    v_pk_add_f32 v[162:163], v[162:163], v[198:199]
    v_perm_b32 v203, v201, v200, s92
    v_perm_b32 v203, v202, v203, s93
    v_perm_b32 v207, v205, v204, s92
    v_perm_b32 v207, v206, v207, s93
    v_pk_add_f32 v[156:157], v[156:157], v[200:201]
    v_pk_add_f32 v[158:159], v[158:159], v[202:203]
    v_pk_add_f32 v[160:161], v[160:161], v[204:205]
    v_pk_add_f32 v[162:163], v[162:163], v[206:207]
    v_perm_b32 v211, v209, v208, s92
    v_perm_b32 v211, v210, v211, s93
    v_perm_b32 v215, v213, v212, s92
    v_perm_b32 v215, v214, v215, s93
    v_pk_add_f32 v[164:165], v[164:165], v[208:209]
    v_pk_add_f32 v[166:167], v[166:167], v[210:211]
    v_pk_add_f32 v[168:169], v[168:169], v[212:213]
    v_pk_add_f32 v[170:171], v[170:171], v[214:215]
    v_perm_b32 v219, v217, v216, s92
    v_perm_b32 v219, v218, v219, s93
    v_perm_b32 v223, v221, v220, s92
    v_perm_b32 v223, v222, v223, s93
    v_pk_add_f32 v[164:165], v[164:165], v[216:217]
    v_pk_add_f32 v[166:167], v[166:167], v[218:219]
    v_pk_add_f32 v[168:169], v[168:169], v[220:221]
    v_pk_add_f32 v[170:171], v[170:171], v[222:223]
    v_perm_b32 v227, v225, v224, s92
    v_perm_b32 v227, v226, v227, s93
    v_perm_b32 v231, v229, v228, s92
    v_perm_b32 v231, v230, v231, s93
    v_pk_add_f32 v[164:165], v[164:165], v[224:225]
    v_pk_add_f32 v[166:167], v[166:167], v[226:227]
    v_pk_add_f32 v[168:169], v[168:169], v[228:229]
    v_pk_add_f32 v[170:171], v[170:171], v[230:231]
    v_perm_b32 v235, v233, v232, s92
    v_perm_b32 v235, v234, v235, s93
    v_perm_b32 v239, v237, v236, s92
    v_perm_b32 v239, v238, v239, s93
    v_pk_add_f32 v[164:165], v[164:165], v[232:233]
    v_pk_add_f32 v[166:167], v[166:167], v[234:235]
    v_pk_add_f32 v[168:169], v[168:169], v[236:237]
    v_pk_add_f32 v[170:171], v[170:171], v[238:239]
    v_mov_b32 v3, 0
    v_mov_b32 v5, 0
    v_cvt_pk_bf16_f32 v4, v156, v157
    v_lshlrev_b32 v156, 16, v4
    v_and_b32 v157, 0xffff0000, v4
    v_pk_add_f32 v[156:157], v[156:157], v[12:13]
    v_cvt_pk_bf16_f32 v4, v156, v157
    v_lshlrev_b32 v156, 16, v4
    v_and_b32 v157, 0xffff0000, v4
    v_cmp_lt_f32 vcc, 0, v156
    v_cmp_lt_f32 s[92:93], 0, v157
    s_nop 0
    v_cndmask_b32 v10, 0, 1.0, vcc
    v_cndmask_b32 v11, 0, 1.0, s[92:93]
    v_mul_f32 v156, v156, v10
    v_mul_f32 v157, v157, v11
    v_fmac_f32 v3, v156, v28
    v_fmac_f32 v5, v157, v29
    v_cvt_pk_bf16_f32 v4, v158, v159
    v_lshlrev_b32 v158, 16, v4
    v_and_b32 v159, 0xffff0000, v4
    v_pk_add_f32 v[158:159], v[158:159], v[14:15]
    v_cvt_pk_bf16_f32 v4, v158, v159
    v_lshlrev_b32 v158, 16, v4
    v_and_b32 v159, 0xffff0000, v4
    v_cmp_lt_f32 vcc, 0, v158
    v_cmp_lt_f32 s[92:93], 0, v159
    s_nop 0
    v_cndmask_b32 v10, 0, 1.0, vcc
    v_cndmask_b32 v11, 0, 1.0, s[92:93]
    v_mul_f32 v158, v158, v10
    v_mul_f32 v159, v159, v11
    v_fmac_f32 v3, v158, v30
    v_fmac_f32 v5, v159, v31
    v_cvt_pk_bf16_f32 v4, v160, v161
    v_lshlrev_b32 v160, 16, v4
    v_and_b32 v161, 0xffff0000, v4
    v_pk_add_f32 v[160:161], v[160:161], v[16:17]
    v_cvt_pk_bf16_f32 v4, v160, v161
    v_lshlrev_b32 v160, 16, v4
    v_and_b32 v161, 0xffff0000, v4
    v_cmp_lt_f32 vcc, 0, v160
    v_cmp_lt_f32 s[92:93], 0, v161
    s_nop 0
    v_cndmask_b32 v10, 0, 1.0, vcc
    v_cndmask_b32 v11, 0, 1.0, s[92:93]
    v_mul_f32 v160, v160, v10
    v_mul_f32 v161, v161, v11
    v_fmac_f32 v3, v160, v32
    v_fmac_f32 v5, v161, v33
    v_cvt_pk_bf16_f32 v4, v162, v163
    v_lshlrev_b32 v162, 16, v4
    v_and_b32 v163, 0xffff0000, v4
    v_pk_add_f32 v[162:163], v[162:163], v[18:19]
    v_cvt_pk_bf16_f32 v4, v162, v163
    v_lshlrev_b32 v162, 16, v4
    v_and_b32 v163, 0xffff0000, v4
    v_cmp_lt_f32 vcc, 0, v162
    v_cmp_lt_f32 s[92:93], 0, v163
    s_nop 0
    v_cndmask_b32 v10, 0, 1.0, vcc
    v_cndmask_b32 v11, 0, 1.0, s[92:93]
    v_mul_f32 v162, v162, v10
    v_mul_f32 v163, v163, v11
    v_fmac_f32 v3, v162, v34
    v_fmac_f32 v5, v163, v35
    v_cvt_pk_bf16_f32 v4, v164, v165
    v_lshlrev_b32 v164, 16, v4
    v_and_b32 v165, 0xffff0000, v4
    v_pk_add_f32 v[164:165], v[164:165], v[20:21]
    v_cvt_pk_bf16_f32 v4, v164, v165
    v_lshlrev_b32 v164, 16, v4
    v_and_b32 v165, 0xffff0000, v4
    v_cmp_lt_f32 vcc, 0, v164
    v_cmp_lt_f32 s[92:93], 0, v165
    s_nop 0
    v_cndmask_b32 v10, 0, 1.0, vcc
    v_cndmask_b32 v11, 0, 1.0, s[92:93]
    v_mul_f32 v164, v164, v10
    v_mul_f32 v165, v165, v11
    v_fmac_f32 v3, v164, v36
    v_fmac_f32 v5, v165, v37
    v_cvt_pk_bf16_f32 v4, v166, v167
    v_lshlrev_b32 v166, 16, v4
    v_and_b32 v167, 0xffff0000, v4
    v_pk_add_f32 v[166:167], v[166:167], v[22:23]
    v_cvt_pk_bf16_f32 v4, v166, v167
    v_lshlrev_b32 v166, 16, v4
    v_and_b32 v167, 0xffff0000, v4
    v_cmp_lt_f32 vcc, 0, v166
    v_cmp_lt_f32 s[92:93], 0, v167
    s_nop 0
    v_cndmask_b32 v10, 0, 1.0, vcc
    v_cndmask_b32 v11, 0, 1.0, s[92:93]
    v_mul_f32 v166, v166, v10
    v_mul_f32 v167, v167, v11
    v_fmac_f32 v3, v166, v38
    v_fmac_f32 v5, v167, v39
    v_cvt_pk_bf16_f32 v4, v168, v169
    v_lshlrev_b32 v168, 16, v4
    v_and_b32 v169, 0xffff0000, v4
    v_pk_add_f32 v[168:169], v[168:169], v[24:25]
    v_cvt_pk_bf16_f32 v4, v168, v169
    v_lshlrev_b32 v168, 16, v4
    v_and_b32 v169, 0xffff0000, v4
    v_cmp_lt_f32 vcc, 0, v168
    v_cmp_lt_f32 s[92:93], 0, v169
    s_nop 0
    v_cndmask_b32 v10, 0, 1.0, vcc
    v_cndmask_b32 v11, 0, 1.0, s[92:93]
    v_mul_f32 v168, v168, v10
    v_mul_f32 v169, v169, v11
    v_fmac_f32 v3, v168, v40
    v_fmac_f32 v5, v169, v41
    v_cvt_pk_bf16_f32 v4, v170, v171
    v_lshlrev_b32 v170, 16, v4
    v_and_b32 v171, 0xffff0000, v4
    v_pk_add_f32 v[170:171], v[170:171], v[26:27]
    v_cvt_pk_bf16_f32 v4, v170, v171
    v_lshlrev_b32 v170, 16, v4
    v_and_b32 v171, 0xffff0000, v4
    v_cmp_lt_f32 vcc, 0, v170
    v_cmp_lt_f32 s[92:93], 0, v171
    s_nop 0
    v_cndmask_b32 v10, 0, 1.0, vcc
    v_cndmask_b32 v11, 0, 1.0, s[92:93]
    v_mul_f32 v170, v170, v10
    v_mul_f32 v171, v171, v11
    v_fmac_f32 v3, v170, v42
    v_fmac_f32 v5, v171, v43
    v_add_f32 v3, v3, v5
    v_mov_b32 v4, v3
    s_nop 1
    v_permlane32_swap_b32 v3, v4
    s_nop 1
    v_add_f32 v3, v3, v4
    v_mov_b32 v4, v3
    s_nop 1
    v_permlane16_swap_b32 v3, v4
    s_nop 1
    v_add_f32 v3, v3, v4
    v_and_b32 v4, 15, v1
    v_lshlrev_b32 v4, 4, v4
    s_lshl_b32 s61, s55, 2
    v_add_u32 v5, s61, v4
    s_mov_b64 exec, 0xffff
    ds_write_b32 v5, v3 offset:16384
    s_waitcnt lgkmcnt(0)
    s_barrier
    s_cmp_lg_u32 s55, 0
    s_cbranch_scc1 L_end
    ds_read_b128 v[156:159], v4 offset:16384
    s_waitcnt lgkmcnt(0)
    v_add_f32 v156, v156, v157
    v_add_f32 v158, v158, v159
    v_add_f32 v156, v156, v158
    v_cvt_pk_bf16_f32 v156, v156, v156
    v_lshlrev_b32 v156, 16, v156
    v_add_f32 v156, v156, v149
    v_cvt_pk_bf16_f32 v156, v156, v156
    v_lshlrev_b32 v156, 16, v156
    v_add_f32 v156, v156, v2
    v_cvt_pk_bf16_f32 v156, v156, v156
    v_lshlrev_b32 v156, 16, v156
    v_mul_f32 v156, 0xbfb8aa3b, v156
    v_exp_f32 v156, v156
    s_nop 0
    v_add_f32 v156, 1.0, v156
    v_rcp_f32 v156, v156
    s_nop 0
    v_cvt_pk_bf16_f32 v156, v156, v156
    v_lshlrev_b32 v4, 1, v1
    s_lshl_b32 s61, s63, 5
    buffer_store_short v156, v4, s[48:51], s61 offen sc1
    s_endpgm
L_compute:
    v_and_b32 v3, 15, v1
    v_lshrrev_b32 v4, 4, v1
    v_lshrrev_b32 v5, 1, v3
    v_xor_b32 v5, v5, v4
    v_lshlrev_b32 v5, 4, v5
    v_lshl_add_u32 v8, v3, 7, v5
    v_add_u32 v8, 0x10000, v8
    v_xor_b32 v9, 64, v8
    v_add_u32 v10, 0x10000, v8
    v_add_u32 v11, 0x10000, v9
    v_bfe_u32 v3, v1, 2, 2
    v_and_b32 v5, 1, v4
    v_lshl_or_b32 v5, v5, 2, v3
    v_lshl_add_u32 v3, v4, 3, v3
    v_lshlrev_b32 v3, 8, v3
    v_and_b32 v4, 3, v1
    v_lshl_add_u32 v3, v4, 3, v3
    s_lshl_b32 s59, s55, 1
    s_add_u32 s60, s59, 0
    v_xor_b32 v4, s60, v5
    v_lshl_add_u32 v12, v4, 5, v3
    s_add_u32 s60, s59, 1
    v_xor_b32 v4, s60, v5
    v_lshl_add_u32 v13, v4, 5, v3
    v_mul_u32_u24 v2, 12, v1
    s_mul_i32 s59, s55, 1536
    v_add_u32 v2, s59, v2
    v_mov_b32 v6, 1
    s_add_u32 s59, s54, 1
    v_add_u32 v3, s59, v1
    v_and_b32 v3, 7, v3
    v_mul_u32_u24 v3, 55296, v3
    s_mul_i32 s59, s66, 49152
    s_lshl_b32 s60, s54, 7
    s_add_u32 s59, s59, s60
    v_add_u32 v16, s59, v3
    v_mov_b32 v180, 0
    v_mov_b32 v181, 0
    v_mov_b32 v182, 0
    v_mov_b32 v183, 0
    v_mov_b32 v184, 0
    v_mov_b32 v185, 0
    v_mov_b32 v186, 0
    v_mov_b32 v187, 0
    v_mov_b32 v188, 0
    v_mov_b32 v189, 0
    v_mov_b32 v190, 0
    v_mov_b32 v191, 0
    v_mov_b32 v192, 0
    v_mov_b32 v193, 0
    v_mov_b32 v194, 0
    v_mov_b32 v195, 0
    v_mov_b32 v196, 0
    v_mov_b32 v197, 0
    v_mov_b32 v198, 0
    v_mov_b32 v199, 0
    v_mov_b32 v200, 0
    v_mov_b32 v201, 0
    v_mov_b32 v202, 0
    v_mov_b32 v203, 0
    v_mov_b32 v204, 0
    v_mov_b32 v205, 0
    v_mov_b32 v206, 0
    v_mov_b32 v207, 0
    v_mov_b32 v208, 0
    v_mov_b32 v209, 0
    v_mov_b32 v210, 0
    v_mov_b32 v211, 0
    v_mov_b32 v212, 0
    v_mov_b32 v213, 0
    v_mov_b32 v214, 0
    v_mov_b32 v215, 0
    v_mov_b32 v216, 0
    v_mov_b32 v217, 0
    v_mov_b32 v218, 0
    v_mov_b32 v219, 0
    v_mov_b32 v220, 0
    v_mov_b32 v221, 0
    v_mov_b32 v222, 0
    v_mov_b32 v223, 0
    v_mov_b32 v224, 0
    v_mov_b32 v225, 0
    v_mov_b32 v226, 0
    v_mov_b32 v227, 0
    v_mov_b32 v228, 0
    v_mov_b32 v229, 0
    v_mov_b32 v230, 0
    v_mov_b32 v231, 0
    v_mov_b32 v232, 0
    v_mov_b32 v233, 0
    v_mov_b32 v234, 0
    v_mov_b32 v235, 0
    v_mov_b32 v236, 0
    v_mov_b32 v237, 0
    v_mov_b32 v238, 0
    v_mov_b32 v239, 0
    v_mov_b32 v240, 0
    v_mov_b32 v241, 0
    v_mov_b32 v242, 0
    v_mov_b32 v243, 0
    s_waitcnt lgkmcnt(0)
    s_mov_b32 s40, s26
    s_and_b32 s41, s27, 0xffff
    s_mov_b32 s42, 0x4000000
    s_mov_b32 s43, 0x00020000
    s_mov_b32 s44, s24
    s_and_b32 s45, s25, 0xffff
    s_mov_b32 s46, 0x200
    s_mov_b32 s47, 0x00020000
    s_mov_b32 s92, 0x07060501
    s_mov_b32 s93, 0x07060502
    s_mov_b32 s94, 0x07060503
    s_barrier
    ds_read_b64_tr_b16 v[84:85], v12 offset:0
    ds_read_b64_tr_b16 v[86:87], v12 offset:1024
    ds_read_b64_tr_b16 v[88:89], v13 offset:0
    ds_read_b64_tr_b16 v[90:91], v13 offset:1024
    ds_read_b128 v[20:23], v8 offset:0
    ds_read_b128 v[24:27], v8 offset:2048
    ds_read_b128 v[28:31], v8 offset:4096
    ds_read_b128 v[32:35], v8 offset:6144
    ds_read_b128 v[36:39], v8 offset:8192
    ds_read_b128 v[40:43], v8 offset:10240
    ds_read_b128 v[44:47], v8 offset:12288
    ds_read_b128 v[48:51], v8 offset:14336
    ds_read_b64_tr_b16 v[92:93], v12 offset:8192
    ds_read_b64_tr_b16 v[94:95], v12 offset:9216
    ds_read_b64_tr_b16 v[96:97], v13 offset:8192
    ds_read_b64_tr_b16 v[98:99], v13 offset:9216
    ds_read_b128 v[52:55], v9 offset:0
    ds_read_b128 v[56:59], v9 offset:2048
    ds_read_b128 v[60:63], v9 offset:4096
    ds_read_b128 v[64:67], v9 offset:6144
    ds_read_b128 v[68:71], v9 offset:8192
    ds_read_b128 v[72:75], v9 offset:10240
    ds_read_b128 v[76:79], v9 offset:12288
    ds_read_b128 v[80:83], v9 offset:14336
    s_waitcnt lgkmcnt(0)
    s_barrier
    v_mfma_f32_16x16x32_bf16 v[180:183], v[84:87], v[20:23], v[180:183]
    ds_read_b64_tr_b16 v[164:165], v12 offset:16384
    v_mfma_f32_16x16x32_bf16 v[184:187], v[88:91], v[20:23], v[184:187]
    ds_read_b64_tr_b16 v[166:167], v12 offset:17408
    v_mfma_f32_16x16x32_bf16 v[188:191], v[84:87], v[24:27], v[188:191]
    ds_read_b64_tr_b16 v[168:169], v13 offset:16384
    v_mfma_f32_16x16x32_bf16 v[192:195], v[88:91], v[24:27], v[192:195]
    ds_read_b64_tr_b16 v[170:171], v13 offset:17408
    v_mfma_f32_16x16x32_bf16 v[196:199], v[84:87], v[28:31], v[196:199]
    ds_read_b128 v[100:103], v8 offset:16384
    v_mfma_f32_16x16x32_bf16 v[200:203], v[88:91], v[28:31], v[200:203]
    ds_read_b128 v[104:107], v8 offset:18432
    v_mfma_f32_16x16x32_bf16 v[204:207], v[84:87], v[32:35], v[204:207]
    ds_read_b128 v[108:111], v8 offset:20480
    v_mfma_f32_16x16x32_bf16 v[208:211], v[88:91], v[32:35], v[208:211]
    ds_read_b128 v[112:115], v8 offset:22528
    v_mfma_f32_16x16x32_bf16 v[212:215], v[84:87], v[36:39], v[212:215]
    ds_read_b128 v[116:119], v8 offset:24576
    v_mfma_f32_16x16x32_bf16 v[216:219], v[88:91], v[36:39], v[216:219]
    ds_read_b128 v[120:123], v8 offset:26624
    v_mfma_f32_16x16x32_bf16 v[220:223], v[84:87], v[40:43], v[220:223]
    ds_read_b128 v[124:127], v8 offset:28672
    v_mfma_f32_16x16x32_bf16 v[224:227], v[88:91], v[40:43], v[224:227]
    ds_read_b128 v[128:131], v8 offset:30720
    v_mfma_f32_16x16x32_bf16 v[228:231], v[84:87], v[44:47], v[228:231]
    ds_read_b64_tr_b16 v[172:173], v12 offset:24576
    v_mfma_f32_16x16x32_bf16 v[232:235], v[88:91], v[44:47], v[232:235]
    ds_read_b64_tr_b16 v[174:175], v12 offset:25600
    v_mfma_f32_16x16x32_bf16 v[236:239], v[84:87], v[48:51], v[236:239]
    ds_read_b64_tr_b16 v[176:177], v13 offset:24576
    v_mfma_f32_16x16x32_bf16 v[240:243], v[88:91], v[48:51], v[240:243]
    ds_read_b64_tr_b16 v[178:179], v13 offset:25600
    v_mfma_f32_16x16x32_bf16 v[180:183], v[92:95], v[52:55], v[180:183]
    ds_read_b128 v[132:135], v9 offset:16384
    v_mfma_f32_16x16x32_bf16 v[184:187], v[96:99], v[52:55], v[184:187]
    ds_read_b128 v[136:139], v9 offset:18432
    v_mfma_f32_16x16x32_bf16 v[188:191], v[92:95], v[56:59], v[188:191]
    ds_read_b128 v[140:143], v9 offset:20480
    v_mfma_f32_16x16x32_bf16 v[192:195], v[96:99], v[56:59], v[192:195]
    ds_read_b128 v[144:147], v9 offset:22528
    v_mfma_f32_16x16x32_bf16 v[196:199], v[92:95], v[60:63], v[196:199]
    ds_read_b128 v[148:151], v9 offset:24576
    v_mfma_f32_16x16x32_bf16 v[200:203], v[96:99], v[60:63], v[200:203]
    ds_read_b128 v[152:155], v9 offset:26624
    v_mfma_f32_16x16x32_bf16 v[204:207], v[92:95], v[64:67], v[204:207]
    ds_read_b128 v[156:159], v9 offset:28672
    v_mfma_f32_16x16x32_bf16 v[208:211], v[96:99], v[64:67], v[208:211]
    ds_read_b128 v[160:163], v9 offset:30720
    v_mfma_f32_16x16x32_bf16 v[212:215], v[92:95], v[68:71], v[212:215]
    v_mfma_f32_16x16x32_bf16 v[216:219], v[96:99], v[68:71], v[216:219]
    v_mfma_f32_16x16x32_bf16 v[220:223], v[92:95], v[72:75], v[220:223]
    v_mfma_f32_16x16x32_bf16 v[224:227], v[96:99], v[72:75], v[224:227]
    v_mfma_f32_16x16x32_bf16 v[228:231], v[92:95], v[76:79], v[228:231]
    v_mfma_f32_16x16x32_bf16 v[232:235], v[96:99], v[76:79], v[232:235]
    v_mfma_f32_16x16x32_bf16 v[236:239], v[92:95], v[80:83], v[236:239]
    v_mfma_f32_16x16x32_bf16 v[240:243], v[96:99], v[80:83], v[240:243]
    s_waitcnt lgkmcnt(0)
    s_barrier
    v_mfma_f32_16x16x32_bf16 v[180:183], v[164:167], v[100:103], v[180:183]
    ds_read_b64_tr_b16 v[84:85], v12 offset:32768
    v_mfma_f32_16x16x32_bf16 v[184:187], v[168:171], v[100:103], v[184:187]
    ds_read_b64_tr_b16 v[86:87], v12 offset:33792
    v_mfma_f32_16x16x32_bf16 v[188:191], v[164:167], v[104:107], v[188:191]
    ds_read_b64_tr_b16 v[88:89], v13 offset:32768
    v_mfma_f32_16x16x32_bf16 v[192:195], v[168:171], v[104:107], v[192:195]
    ds_read_b64_tr_b16 v[90:91], v13 offset:33792
    v_mfma_f32_16x16x32_bf16 v[196:199], v[164:167], v[108:111], v[196:199]
    ds_read_b128 v[20:23], v8 offset:32768
    v_mfma_f32_16x16x32_bf16 v[200:203], v[168:171], v[108:111], v[200:203]
    ds_read_b128 v[24:27], v8 offset:34816
    v_mfma_f32_16x16x32_bf16 v[204:207], v[164:167], v[112:115], v[204:207]
    ds_read_b128 v[28:31], v8 offset:36864
    v_mfma_f32_16x16x32_bf16 v[208:211], v[168:171], v[112:115], v[208:211]
    ds_read_b128 v[32:35], v8 offset:38912
    v_mfma_f32_16x16x32_bf16 v[212:215], v[164:167], v[116:119], v[212:215]
    ds_read_b128 v[36:39], v8 offset:40960
    v_mfma_f32_16x16x32_bf16 v[216:219], v[168:171], v[116:119], v[216:219]
    ds_read_b128 v[40:43], v8 offset:43008
    v_mfma_f32_16x16x32_bf16 v[220:223], v[164:167], v[120:123], v[220:223]
    ds_read_b128 v[44:47], v8 offset:45056
    v_mfma_f32_16x16x32_bf16 v[224:227], v[168:171], v[120:123], v[224:227]
    ds_read_b128 v[48:51], v8 offset:47104
    v_mfma_f32_16x16x32_bf16 v[228:231], v[164:167], v[124:127], v[228:231]
    ds_read_b64_tr_b16 v[92:93], v12 offset:40960
    v_mfma_f32_16x16x32_bf16 v[232:235], v[168:171], v[124:127], v[232:235]
    ds_read_b64_tr_b16 v[94:95], v12 offset:41984
    v_mfma_f32_16x16x32_bf16 v[236:239], v[164:167], v[128:131], v[236:239]
    ds_read_b64_tr_b16 v[96:97], v13 offset:40960
    v_mfma_f32_16x16x32_bf16 v[240:243], v[168:171], v[128:131], v[240:243]
    ds_read_b64_tr_b16 v[98:99], v13 offset:41984
    v_mfma_f32_16x16x32_bf16 v[180:183], v[172:175], v[132:135], v[180:183]
    ds_read_b128 v[52:55], v9 offset:32768
    v_mfma_f32_16x16x32_bf16 v[184:187], v[176:179], v[132:135], v[184:187]
    ds_read_b128 v[56:59], v9 offset:34816
    v_mfma_f32_16x16x32_bf16 v[188:191], v[172:175], v[136:139], v[188:191]
    ds_read_b128 v[60:63], v9 offset:36864
    v_mfma_f32_16x16x32_bf16 v[192:195], v[176:179], v[136:139], v[192:195]
    ds_read_b128 v[64:67], v9 offset:38912
    v_mfma_f32_16x16x32_bf16 v[196:199], v[172:175], v[140:143], v[196:199]
    ds_read_b128 v[68:71], v9 offset:40960
    v_mfma_f32_16x16x32_bf16 v[200:203], v[176:179], v[140:143], v[200:203]
    ds_read_b128 v[72:75], v9 offset:43008
    v_mfma_f32_16x16x32_bf16 v[204:207], v[172:175], v[144:147], v[204:207]
    ds_read_b128 v[76:79], v9 offset:45056
    v_mfma_f32_16x16x32_bf16 v[208:211], v[176:179], v[144:147], v[208:211]
    ds_read_b128 v[80:83], v9 offset:47104
    v_mfma_f32_16x16x32_bf16 v[212:215], v[172:175], v[148:151], v[212:215]
    v_mfma_f32_16x16x32_bf16 v[216:219], v[176:179], v[148:151], v[216:219]
    v_mfma_f32_16x16x32_bf16 v[220:223], v[172:175], v[152:155], v[220:223]
    v_mfma_f32_16x16x32_bf16 v[224:227], v[176:179], v[152:155], v[224:227]
    v_mfma_f32_16x16x32_bf16 v[228:231], v[172:175], v[156:159], v[228:231]
    v_mfma_f32_16x16x32_bf16 v[232:235], v[176:179], v[156:159], v[232:235]
    v_mfma_f32_16x16x32_bf16 v[236:239], v[172:175], v[160:163], v[236:239]
    v_mfma_f32_16x16x32_bf16 v[240:243], v[176:179], v[160:163], v[240:243]
    s_waitcnt lgkmcnt(0)
    s_barrier
    v_mfma_f32_16x16x32_bf16 v[180:183], v[84:87], v[20:23], v[180:183]
    ds_read_b64_tr_b16 v[164:165], v12 offset:49152
    v_mfma_f32_16x16x32_bf16 v[184:187], v[88:91], v[20:23], v[184:187]
    ds_read_b64_tr_b16 v[166:167], v12 offset:50176
    v_mfma_f32_16x16x32_bf16 v[188:191], v[84:87], v[24:27], v[188:191]
    ds_read_b64_tr_b16 v[168:169], v13 offset:49152
    v_mfma_f32_16x16x32_bf16 v[192:195], v[88:91], v[24:27], v[192:195]
    ds_read_b64_tr_b16 v[170:171], v13 offset:50176
    v_mfma_f32_16x16x32_bf16 v[196:199], v[84:87], v[28:31], v[196:199]
    ds_read_b128 v[100:103], v8 offset:49152
    v_mfma_f32_16x16x32_bf16 v[200:203], v[88:91], v[28:31], v[200:203]
    ds_read_b128 v[104:107], v8 offset:51200
    v_mfma_f32_16x16x32_bf16 v[204:207], v[84:87], v[32:35], v[204:207]
    ds_read_b128 v[108:111], v8 offset:53248
    v_mfma_f32_16x16x32_bf16 v[208:211], v[88:91], v[32:35], v[208:211]
    ds_read_b128 v[112:115], v8 offset:55296
    v_mfma_f32_16x16x32_bf16 v[212:215], v[84:87], v[36:39], v[212:215]
    ds_read_b128 v[116:119], v8 offset:57344
    v_mfma_f32_16x16x32_bf16 v[216:219], v[88:91], v[36:39], v[216:219]
    ds_read_b128 v[120:123], v8 offset:59392
    v_mfma_f32_16x16x32_bf16 v[220:223], v[84:87], v[40:43], v[220:223]
    ds_read_b128 v[124:127], v8 offset:61440
    v_mfma_f32_16x16x32_bf16 v[224:227], v[88:91], v[40:43], v[224:227]
    ds_read_b128 v[128:131], v8 offset:63488
    v_mfma_f32_16x16x32_bf16 v[228:231], v[84:87], v[44:47], v[228:231]
    ds_read_b64_tr_b16 v[172:173], v12 offset:57344
    v_mfma_f32_16x16x32_bf16 v[232:235], v[88:91], v[44:47], v[232:235]
    ds_read_b64_tr_b16 v[174:175], v12 offset:58368
    v_mfma_f32_16x16x32_bf16 v[236:239], v[84:87], v[48:51], v[236:239]
    ds_read_b64_tr_b16 v[176:177], v13 offset:57344
    v_mfma_f32_16x16x32_bf16 v[240:243], v[88:91], v[48:51], v[240:243]
    ds_read_b64_tr_b16 v[178:179], v13 offset:58368
    v_mfma_f32_16x16x32_bf16 v[180:183], v[92:95], v[52:55], v[180:183]
    ds_read_b128 v[132:135], v9 offset:49152
    v_mfma_f32_16x16x32_bf16 v[184:187], v[96:99], v[52:55], v[184:187]
    ds_read_b128 v[136:139], v9 offset:51200
    v_mfma_f32_16x16x32_bf16 v[188:191], v[92:95], v[56:59], v[188:191]
    ds_read_b128 v[140:143], v9 offset:53248
    v_mfma_f32_16x16x32_bf16 v[192:195], v[96:99], v[56:59], v[192:195]
    ds_read_b128 v[144:147], v9 offset:55296
    v_mfma_f32_16x16x32_bf16 v[196:199], v[92:95], v[60:63], v[196:199]
    ds_read_b128 v[148:151], v9 offset:57344
    v_mfma_f32_16x16x32_bf16 v[200:203], v[96:99], v[60:63], v[200:203]
    ds_read_b128 v[152:155], v9 offset:59392
    v_mfma_f32_16x16x32_bf16 v[204:207], v[92:95], v[64:67], v[204:207]
    ds_read_b128 v[156:159], v9 offset:61440
    v_mfma_f32_16x16x32_bf16 v[208:211], v[96:99], v[64:67], v[208:211]
    ds_read_b128 v[160:163], v9 offset:63488
    v_mfma_f32_16x16x32_bf16 v[212:215], v[92:95], v[68:71], v[212:215]
    v_mfma_f32_16x16x32_bf16 v[216:219], v[96:99], v[68:71], v[216:219]
    v_mfma_f32_16x16x32_bf16 v[220:223], v[92:95], v[72:75], v[220:223]
    v_mfma_f32_16x16x32_bf16 v[224:227], v[96:99], v[72:75], v[224:227]
    v_mfma_f32_16x16x32_bf16 v[228:231], v[92:95], v[76:79], v[228:231]
    v_mfma_f32_16x16x32_bf16 v[232:235], v[96:99], v[76:79], v[232:235]
    v_mfma_f32_16x16x32_bf16 v[236:239], v[92:95], v[80:83], v[236:239]
    v_mfma_f32_16x16x32_bf16 v[240:243], v[96:99], v[80:83], v[240:243]
    s_waitcnt lgkmcnt(0)
    s_barrier
    v_mfma_f32_16x16x32_bf16 v[180:183], v[164:167], v[100:103], v[180:183]
    ds_read_b64_tr_b16 v[84:85], v12 offset:0
    v_mfma_f32_16x16x32_bf16 v[184:187], v[168:171], v[100:103], v[184:187]
    ds_read_b64_tr_b16 v[86:87], v12 offset:1024
    v_mfma_f32_16x16x32_bf16 v[188:191], v[164:167], v[104:107], v[188:191]
    ds_read_b64_tr_b16 v[88:89], v13 offset:0
    v_mfma_f32_16x16x32_bf16 v[192:195], v[168:171], v[104:107], v[192:195]
    ds_read_b64_tr_b16 v[90:91], v13 offset:1024
    v_mfma_f32_16x16x32_bf16 v[196:199], v[164:167], v[108:111], v[196:199]
    ds_read_b128 v[20:23], v10 offset:0
    v_mfma_f32_16x16x32_bf16 v[200:203], v[168:171], v[108:111], v[200:203]
    ds_read_b128 v[24:27], v10 offset:2048
    v_mfma_f32_16x16x32_bf16 v[204:207], v[164:167], v[112:115], v[204:207]
    ds_read_b128 v[28:31], v10 offset:4096
    v_mfma_f32_16x16x32_bf16 v[208:211], v[168:171], v[112:115], v[208:211]
    ds_read_b128 v[32:35], v10 offset:6144
    v_mfma_f32_16x16x32_bf16 v[212:215], v[164:167], v[116:119], v[212:215]
    ds_read_b128 v[36:39], v10 offset:8192
    v_mfma_f32_16x16x32_bf16 v[216:219], v[168:171], v[116:119], v[216:219]
    ds_read_b128 v[40:43], v10 offset:10240
    v_mfma_f32_16x16x32_bf16 v[220:223], v[164:167], v[120:123], v[220:223]
    ds_read_b128 v[44:47], v10 offset:12288
    v_mfma_f32_16x16x32_bf16 v[224:227], v[168:171], v[120:123], v[224:227]
    ds_read_b128 v[48:51], v10 offset:14336
    v_mfma_f32_16x16x32_bf16 v[228:231], v[164:167], v[124:127], v[228:231]
    ds_read_b64_tr_b16 v[92:93], v12 offset:8192
    v_mfma_f32_16x16x32_bf16 v[232:235], v[168:171], v[124:127], v[232:235]
    ds_read_b64_tr_b16 v[94:95], v12 offset:9216
    v_mfma_f32_16x16x32_bf16 v[236:239], v[164:167], v[128:131], v[236:239]
    ds_read_b64_tr_b16 v[96:97], v13 offset:8192
    v_mfma_f32_16x16x32_bf16 v[240:243], v[168:171], v[128:131], v[240:243]
    ds_read_b64_tr_b16 v[98:99], v13 offset:9216
    v_mfma_f32_16x16x32_bf16 v[180:183], v[172:175], v[132:135], v[180:183]
    ds_read_b128 v[52:55], v11 offset:0
    v_mfma_f32_16x16x32_bf16 v[184:187], v[176:179], v[132:135], v[184:187]
    ds_read_b128 v[56:59], v11 offset:2048
    v_mfma_f32_16x16x32_bf16 v[188:191], v[172:175], v[136:139], v[188:191]
    ds_read_b128 v[60:63], v11 offset:4096
    v_mfma_f32_16x16x32_bf16 v[192:195], v[176:179], v[136:139], v[192:195]
    ds_read_b128 v[64:67], v11 offset:6144
    v_mfma_f32_16x16x32_bf16 v[196:199], v[172:175], v[140:143], v[196:199]
    ds_read_b128 v[68:71], v11 offset:8192
    v_mfma_f32_16x16x32_bf16 v[200:203], v[176:179], v[140:143], v[200:203]
    ds_read_b128 v[72:75], v11 offset:10240
    v_mfma_f32_16x16x32_bf16 v[204:207], v[172:175], v[144:147], v[204:207]
    ds_read_b128 v[76:79], v11 offset:12288
    v_mfma_f32_16x16x32_bf16 v[208:211], v[176:179], v[144:147], v[208:211]
    ds_read_b128 v[80:83], v11 offset:14336
    v_mfma_f32_16x16x32_bf16 v[212:215], v[172:175], v[148:151], v[212:215]
    v_mfma_f32_16x16x32_bf16 v[216:219], v[176:179], v[148:151], v[216:219]
    v_mfma_f32_16x16x32_bf16 v[220:223], v[172:175], v[152:155], v[220:223]
    v_mfma_f32_16x16x32_bf16 v[224:227], v[176:179], v[152:155], v[224:227]
    v_mfma_f32_16x16x32_bf16 v[228:231], v[172:175], v[156:159], v[228:231]
    v_mfma_f32_16x16x32_bf16 v[232:235], v[176:179], v[156:159], v[232:235]
    v_mfma_f32_16x16x32_bf16 v[236:239], v[172:175], v[160:163], v[236:239]
    v_mfma_f32_16x16x32_bf16 v[240:243], v[176:179], v[160:163], v[240:243]
    s_waitcnt lgkmcnt(0)
    s_barrier
    v_mfma_f32_16x16x32_bf16 v[180:183], v[84:87], v[20:23], v[180:183]
    ds_read_b64_tr_b16 v[164:165], v12 offset:16384
    v_mfma_f32_16x16x32_bf16 v[184:187], v[88:91], v[20:23], v[184:187]
    ds_read_b64_tr_b16 v[166:167], v12 offset:17408
    v_mfma_f32_16x16x32_bf16 v[188:191], v[84:87], v[24:27], v[188:191]
    ds_read_b64_tr_b16 v[168:169], v13 offset:16384
    v_mfma_f32_16x16x32_bf16 v[192:195], v[88:91], v[24:27], v[192:195]
    ds_read_b64_tr_b16 v[170:171], v13 offset:17408
    v_mfma_f32_16x16x32_bf16 v[196:199], v[84:87], v[28:31], v[196:199]
    ds_read_b128 v[100:103], v10 offset:16384
    v_mfma_f32_16x16x32_bf16 v[200:203], v[88:91], v[28:31], v[200:203]
    ds_read_b128 v[104:107], v10 offset:18432
    v_mfma_f32_16x16x32_bf16 v[204:207], v[84:87], v[32:35], v[204:207]
    ds_read_b128 v[108:111], v10 offset:20480
    v_mfma_f32_16x16x32_bf16 v[208:211], v[88:91], v[32:35], v[208:211]
    ds_read_b128 v[112:115], v10 offset:22528
    v_mfma_f32_16x16x32_bf16 v[212:215], v[84:87], v[36:39], v[212:215]
    ds_read_b128 v[116:119], v10 offset:24576
    v_mfma_f32_16x16x32_bf16 v[216:219], v[88:91], v[36:39], v[216:219]
    ds_read_b128 v[120:123], v10 offset:26624
    v_mfma_f32_16x16x32_bf16 v[220:223], v[84:87], v[40:43], v[220:223]
    ds_read_b128 v[124:127], v10 offset:28672
    v_mfma_f32_16x16x32_bf16 v[224:227], v[88:91], v[40:43], v[224:227]
    ds_read_b128 v[128:131], v10 offset:30720
    v_mfma_f32_16x16x32_bf16 v[228:231], v[84:87], v[44:47], v[228:231]
    ds_read_b64_tr_b16 v[172:173], v12 offset:24576
    v_mfma_f32_16x16x32_bf16 v[232:235], v[88:91], v[44:47], v[232:235]
    ds_read_b64_tr_b16 v[174:175], v12 offset:25600
    v_mfma_f32_16x16x32_bf16 v[236:239], v[84:87], v[48:51], v[236:239]
    ds_read_b64_tr_b16 v[176:177], v13 offset:24576
    v_mfma_f32_16x16x32_bf16 v[240:243], v[88:91], v[48:51], v[240:243]
    ds_read_b64_tr_b16 v[178:179], v13 offset:25600
    v_mfma_f32_16x16x32_bf16 v[180:183], v[92:95], v[52:55], v[180:183]
    ds_read_b128 v[132:135], v11 offset:16384
    v_mfma_f32_16x16x32_bf16 v[184:187], v[96:99], v[52:55], v[184:187]
    ds_read_b128 v[136:139], v11 offset:18432
    v_mfma_f32_16x16x32_bf16 v[188:191], v[92:95], v[56:59], v[188:191]
    ds_read_b128 v[140:143], v11 offset:20480
    v_mfma_f32_16x16x32_bf16 v[192:195], v[96:99], v[56:59], v[192:195]
    ds_read_b128 v[144:147], v11 offset:22528
    v_mfma_f32_16x16x32_bf16 v[196:199], v[92:95], v[60:63], v[196:199]
    ds_read_b128 v[148:151], v11 offset:24576
    v_mfma_f32_16x16x32_bf16 v[200:203], v[96:99], v[60:63], v[200:203]
    ds_read_b128 v[152:155], v11 offset:26624
    v_mfma_f32_16x16x32_bf16 v[204:207], v[92:95], v[64:67], v[204:207]
    ds_read_b128 v[156:159], v11 offset:28672
    v_mfma_f32_16x16x32_bf16 v[208:211], v[96:99], v[64:67], v[208:211]
    ds_read_b128 v[160:163], v11 offset:30720
    v_mfma_f32_16x16x32_bf16 v[212:215], v[92:95], v[68:71], v[212:215]
    v_mfma_f32_16x16x32_bf16 v[216:219], v[96:99], v[68:71], v[216:219]
    v_mfma_f32_16x16x32_bf16 v[220:223], v[92:95], v[72:75], v[220:223]
    v_mfma_f32_16x16x32_bf16 v[224:227], v[96:99], v[72:75], v[224:227]
    v_mfma_f32_16x16x32_bf16 v[228:231], v[92:95], v[76:79], v[228:231]
    v_mfma_f32_16x16x32_bf16 v[232:235], v[96:99], v[76:79], v[232:235]
    v_mfma_f32_16x16x32_bf16 v[236:239], v[92:95], v[80:83], v[236:239]
    v_mfma_f32_16x16x32_bf16 v[240:243], v[96:99], v[80:83], v[240:243]
    s_waitcnt lgkmcnt(0)
    s_barrier
    v_mfma_f32_16x16x32_bf16 v[180:183], v[164:167], v[100:103], v[180:183]
    ds_read_b64_tr_b16 v[84:85], v12 offset:32768
    v_mfma_f32_16x16x32_bf16 v[184:187], v[168:171], v[100:103], v[184:187]
    ds_read_b64_tr_b16 v[86:87], v12 offset:33792
    v_mfma_f32_16x16x32_bf16 v[188:191], v[164:167], v[104:107], v[188:191]
    ds_read_b64_tr_b16 v[88:89], v13 offset:32768
    v_mfma_f32_16x16x32_bf16 v[192:195], v[168:171], v[104:107], v[192:195]
    ds_read_b64_tr_b16 v[90:91], v13 offset:33792
    v_mfma_f32_16x16x32_bf16 v[196:199], v[164:167], v[108:111], v[196:199]
    ds_read_b128 v[20:23], v8 offset:0
    v_mfma_f32_16x16x32_bf16 v[200:203], v[168:171], v[108:111], v[200:203]
    ds_read_b128 v[24:27], v8 offset:2048
    v_mfma_f32_16x16x32_bf16 v[204:207], v[164:167], v[112:115], v[204:207]
    ds_read_b128 v[28:31], v8 offset:4096
    v_mfma_f32_16x16x32_bf16 v[208:211], v[168:171], v[112:115], v[208:211]
    ds_read_b128 v[32:35], v8 offset:6144
    v_mfma_f32_16x16x32_bf16 v[212:215], v[164:167], v[116:119], v[212:215]
    ds_read_b128 v[36:39], v8 offset:8192
    v_mfma_f32_16x16x32_bf16 v[216:219], v[168:171], v[116:119], v[216:219]
    ds_read_b128 v[40:43], v8 offset:10240
    v_mfma_f32_16x16x32_bf16 v[220:223], v[164:167], v[120:123], v[220:223]
    ds_read_b128 v[44:47], v8 offset:12288
    v_mfma_f32_16x16x32_bf16 v[224:227], v[168:171], v[120:123], v[224:227]
    ds_read_b128 v[48:51], v8 offset:14336
    v_mfma_f32_16x16x32_bf16 v[228:231], v[164:167], v[124:127], v[228:231]
    ds_read_b64_tr_b16 v[92:93], v12 offset:40960
    v_mfma_f32_16x16x32_bf16 v[232:235], v[168:171], v[124:127], v[232:235]
    ds_read_b64_tr_b16 v[94:95], v12 offset:41984
    v_mfma_f32_16x16x32_bf16 v[236:239], v[164:167], v[128:131], v[236:239]
    ds_read_b64_tr_b16 v[96:97], v13 offset:40960
    v_mfma_f32_16x16x32_bf16 v[240:243], v[168:171], v[128:131], v[240:243]
    ds_read_b64_tr_b16 v[98:99], v13 offset:41984
    v_mfma_f32_16x16x32_bf16 v[180:183], v[172:175], v[132:135], v[180:183]
    ds_read_b128 v[52:55], v9 offset:0
    v_mfma_f32_16x16x32_bf16 v[184:187], v[176:179], v[132:135], v[184:187]
    ds_read_b128 v[56:59], v9 offset:2048
    v_mfma_f32_16x16x32_bf16 v[188:191], v[172:175], v[136:139], v[188:191]
    ds_read_b128 v[60:63], v9 offset:4096
    v_mfma_f32_16x16x32_bf16 v[192:195], v[176:179], v[136:139], v[192:195]
    ds_read_b128 v[64:67], v9 offset:6144
    v_mfma_f32_16x16x32_bf16 v[196:199], v[172:175], v[140:143], v[196:199]
    ds_read_b128 v[68:71], v9 offset:8192
    v_mfma_f32_16x16x32_bf16 v[200:203], v[176:179], v[140:143], v[200:203]
    ds_read_b128 v[72:75], v9 offset:10240
    v_mfma_f32_16x16x32_bf16 v[204:207], v[172:175], v[144:147], v[204:207]
    ds_read_b128 v[76:79], v9 offset:12288
    v_mfma_f32_16x16x32_bf16 v[208:211], v[176:179], v[144:147], v[208:211]
    ds_read_b128 v[80:83], v9 offset:14336
    v_mfma_f32_16x16x32_bf16 v[212:215], v[172:175], v[148:151], v[212:215]
    v_mfma_f32_16x16x32_bf16 v[216:219], v[176:179], v[148:151], v[216:219]
    v_mfma_f32_16x16x32_bf16 v[220:223], v[172:175], v[152:155], v[220:223]
    v_mfma_f32_16x16x32_bf16 v[224:227], v[176:179], v[152:155], v[224:227]
    v_mfma_f32_16x16x32_bf16 v[228:231], v[172:175], v[156:159], v[228:231]
    v_mfma_f32_16x16x32_bf16 v[232:235], v[176:179], v[156:159], v[232:235]
    v_mfma_f32_16x16x32_bf16 v[236:239], v[172:175], v[160:163], v[236:239]
    v_mfma_f32_16x16x32_bf16 v[240:243], v[176:179], v[160:163], v[240:243]
    s_waitcnt lgkmcnt(0)
    s_barrier
    v_mfma_f32_16x16x32_bf16 v[180:183], v[84:87], v[20:23], v[180:183]
    ds_read_b64_tr_b16 v[164:165], v12 offset:49152
    v_mfma_f32_16x16x32_bf16 v[184:187], v[88:91], v[20:23], v[184:187]
    ds_read_b64_tr_b16 v[166:167], v12 offset:50176
    v_mfma_f32_16x16x32_bf16 v[188:191], v[84:87], v[24:27], v[188:191]
    ds_read_b64_tr_b16 v[168:169], v13 offset:49152
    v_mfma_f32_16x16x32_bf16 v[192:195], v[88:91], v[24:27], v[192:195]
    ds_read_b64_tr_b16 v[170:171], v13 offset:50176
    v_mfma_f32_16x16x32_bf16 v[196:199], v[84:87], v[28:31], v[196:199]
    ds_read_b128 v[100:103], v8 offset:16384
    v_mfma_f32_16x16x32_bf16 v[200:203], v[88:91], v[28:31], v[200:203]
    ds_read_b128 v[104:107], v8 offset:18432
    v_mfma_f32_16x16x32_bf16 v[204:207], v[84:87], v[32:35], v[204:207]
    ds_read_b128 v[108:111], v8 offset:20480
    v_mfma_f32_16x16x32_bf16 v[208:211], v[88:91], v[32:35], v[208:211]
    ds_read_b128 v[112:115], v8 offset:22528
    v_mfma_f32_16x16x32_bf16 v[212:215], v[84:87], v[36:39], v[212:215]
    ds_read_b128 v[116:119], v8 offset:24576
    v_mfma_f32_16x16x32_bf16 v[216:219], v[88:91], v[36:39], v[216:219]
    ds_read_b128 v[120:123], v8 offset:26624
    v_mfma_f32_16x16x32_bf16 v[220:223], v[84:87], v[40:43], v[220:223]
    ds_read_b128 v[124:127], v8 offset:28672
    v_mfma_f32_16x16x32_bf16 v[224:227], v[88:91], v[40:43], v[224:227]
    ds_read_b128 v[128:131], v8 offset:30720
    v_mfma_f32_16x16x32_bf16 v[228:231], v[84:87], v[44:47], v[228:231]
    ds_read_b64_tr_b16 v[172:173], v12 offset:57344
    v_mfma_f32_16x16x32_bf16 v[232:235], v[88:91], v[44:47], v[232:235]
    ds_read_b64_tr_b16 v[174:175], v12 offset:58368
    v_mfma_f32_16x16x32_bf16 v[236:239], v[84:87], v[48:51], v[236:239]
    ds_read_b64_tr_b16 v[176:177], v13 offset:57344
    v_mfma_f32_16x16x32_bf16 v[240:243], v[88:91], v[48:51], v[240:243]
    ds_read_b64_tr_b16 v[178:179], v13 offset:58368
    v_mfma_f32_16x16x32_bf16 v[180:183], v[92:95], v[52:55], v[180:183]
    ds_read_b128 v[132:135], v9 offset:16384
    v_mfma_f32_16x16x32_bf16 v[184:187], v[96:99], v[52:55], v[184:187]
    ds_read_b128 v[136:139], v9 offset:18432
    v_mfma_f32_16x16x32_bf16 v[188:191], v[92:95], v[56:59], v[188:191]
    ds_read_b128 v[140:143], v9 offset:20480
    v_mfma_f32_16x16x32_bf16 v[192:195], v[96:99], v[56:59], v[192:195]
    ds_read_b128 v[144:147], v9 offset:22528
    v_mfma_f32_16x16x32_bf16 v[196:199], v[92:95], v[60:63], v[196:199]
    ds_read_b128 v[148:151], v9 offset:24576
    v_mfma_f32_16x16x32_bf16 v[200:203], v[96:99], v[60:63], v[200:203]
    ds_read_b128 v[152:155], v9 offset:26624
    v_mfma_f32_16x16x32_bf16 v[204:207], v[92:95], v[64:67], v[204:207]
    ds_read_b128 v[156:159], v9 offset:28672
    v_mfma_f32_16x16x32_bf16 v[208:211], v[96:99], v[64:67], v[208:211]
    ds_read_b128 v[160:163], v9 offset:30720
    v_mfma_f32_16x16x32_bf16 v[212:215], v[92:95], v[68:71], v[212:215]
    v_mfma_f32_16x16x32_bf16 v[216:219], v[96:99], v[68:71], v[216:219]
    v_mfma_f32_16x16x32_bf16 v[220:223], v[92:95], v[72:75], v[220:223]
    v_mfma_f32_16x16x32_bf16 v[224:227], v[96:99], v[72:75], v[224:227]
    v_mfma_f32_16x16x32_bf16 v[228:231], v[92:95], v[76:79], v[228:231]
    v_mfma_f32_16x16x32_bf16 v[232:235], v[96:99], v[76:79], v[232:235]
    v_mfma_f32_16x16x32_bf16 v[236:239], v[92:95], v[80:83], v[236:239]
    v_mfma_f32_16x16x32_bf16 v[240:243], v[96:99], v[80:83], v[240:243]
    s_waitcnt lgkmcnt(0)
    s_barrier
    v_mfma_f32_16x16x32_bf16 v[180:183], v[164:167], v[100:103], v[180:183]
    ds_read_b64_tr_b16 v[84:85], v12 offset:0
    v_mfma_f32_16x16x32_bf16 v[184:187], v[168:171], v[100:103], v[184:187]
    ds_read_b64_tr_b16 v[86:87], v12 offset:1024
    v_mfma_f32_16x16x32_bf16 v[188:191], v[164:167], v[104:107], v[188:191]
    ds_read_b64_tr_b16 v[88:89], v13 offset:0
    v_mfma_f32_16x16x32_bf16 v[192:195], v[168:171], v[104:107], v[192:195]
    ds_read_b64_tr_b16 v[90:91], v13 offset:1024
    v_mfma_f32_16x16x32_bf16 v[196:199], v[164:167], v[108:111], v[196:199]
    ds_read_b128 v[20:23], v8 offset:32768
    v_mfma_f32_16x16x32_bf16 v[200:203], v[168:171], v[108:111], v[200:203]
    ds_read_b128 v[24:27], v8 offset:34816
    v_mfma_f32_16x16x32_bf16 v[204:207], v[164:167], v[112:115], v[204:207]
    ds_read_b128 v[28:31], v8 offset:36864
    v_mfma_f32_16x16x32_bf16 v[208:211], v[168:171], v[112:115], v[208:211]
    ds_read_b128 v[32:35], v8 offset:38912
    v_mfma_f32_16x16x32_bf16 v[212:215], v[164:167], v[116:119], v[212:215]
    ds_read_b128 v[36:39], v8 offset:40960
    v_mfma_f32_16x16x32_bf16 v[216:219], v[168:171], v[116:119], v[216:219]
    ds_read_b128 v[40:43], v8 offset:43008
    v_mfma_f32_16x16x32_bf16 v[220:223], v[164:167], v[120:123], v[220:223]
    ds_read_b128 v[44:47], v8 offset:45056
    v_mfma_f32_16x16x32_bf16 v[224:227], v[168:171], v[120:123], v[224:227]
    ds_read_b128 v[48:51], v8 offset:47104
    v_mfma_f32_16x16x32_bf16 v[228:231], v[164:167], v[124:127], v[228:231]
    ds_read_b64_tr_b16 v[92:93], v12 offset:8192
    v_mfma_f32_16x16x32_bf16 v[232:235], v[168:171], v[124:127], v[232:235]
    ds_read_b64_tr_b16 v[94:95], v12 offset:9216
    v_mfma_f32_16x16x32_bf16 v[236:239], v[164:167], v[128:131], v[236:239]
    ds_read_b64_tr_b16 v[96:97], v13 offset:8192
    v_mfma_f32_16x16x32_bf16 v[240:243], v[168:171], v[128:131], v[240:243]
    ds_read_b64_tr_b16 v[98:99], v13 offset:9216
    v_mfma_f32_16x16x32_bf16 v[180:183], v[172:175], v[132:135], v[180:183]
    ds_read_b128 v[52:55], v9 offset:32768
    v_mfma_f32_16x16x32_bf16 v[184:187], v[176:179], v[132:135], v[184:187]
    ds_read_b128 v[56:59], v9 offset:34816
    v_mfma_f32_16x16x32_bf16 v[188:191], v[172:175], v[136:139], v[188:191]
    ds_read_b128 v[60:63], v9 offset:36864
    v_mfma_f32_16x16x32_bf16 v[192:195], v[176:179], v[136:139], v[192:195]
    ds_read_b128 v[64:67], v9 offset:38912
    v_mfma_f32_16x16x32_bf16 v[196:199], v[172:175], v[140:143], v[196:199]
    ds_read_b128 v[68:71], v9 offset:40960
    v_mfma_f32_16x16x32_bf16 v[200:203], v[176:179], v[140:143], v[200:203]
    ds_read_b128 v[72:75], v9 offset:43008
    v_mfma_f32_16x16x32_bf16 v[204:207], v[172:175], v[144:147], v[204:207]
    ds_read_b128 v[76:79], v9 offset:45056
    v_mfma_f32_16x16x32_bf16 v[208:211], v[176:179], v[144:147], v[208:211]
    ds_read_b128 v[80:83], v9 offset:47104
    v_mfma_f32_16x16x32_bf16 v[212:215], v[172:175], v[148:151], v[212:215]
    v_mfma_f32_16x16x32_bf16 v[216:219], v[176:179], v[148:151], v[216:219]
    v_mfma_f32_16x16x32_bf16 v[220:223], v[172:175], v[152:155], v[220:223]
    v_mfma_f32_16x16x32_bf16 v[224:227], v[176:179], v[152:155], v[224:227]
    v_mfma_f32_16x16x32_bf16 v[228:231], v[172:175], v[156:159], v[228:231]
    v_mfma_f32_16x16x32_bf16 v[232:235], v[176:179], v[156:159], v[232:235]
    v_mfma_f32_16x16x32_bf16 v[236:239], v[172:175], v[160:163], v[236:239]
    v_mfma_f32_16x16x32_bf16 v[240:243], v[176:179], v[160:163], v[240:243]
    s_waitcnt lgkmcnt(0)
    s_barrier
    v_mfma_f32_16x16x32_bf16 v[180:183], v[84:87], v[20:23], v[180:183]
    ds_read_b64_tr_b16 v[164:165], v12 offset:16384
    v_mfma_f32_16x16x32_bf16 v[184:187], v[88:91], v[20:23], v[184:187]
    ds_read_b64_tr_b16 v[166:167], v12 offset:17408
    v_mfma_f32_16x16x32_bf16 v[188:191], v[84:87], v[24:27], v[188:191]
    ds_read_b64_tr_b16 v[168:169], v13 offset:16384
    v_mfma_f32_16x16x32_bf16 v[192:195], v[88:91], v[24:27], v[192:195]
    ds_read_b64_tr_b16 v[170:171], v13 offset:17408
    v_mfma_f32_16x16x32_bf16 v[196:199], v[84:87], v[28:31], v[196:199]
    ds_read_b128 v[100:103], v8 offset:49152
    v_mfma_f32_16x16x32_bf16 v[200:203], v[88:91], v[28:31], v[200:203]
    ds_read_b128 v[104:107], v8 offset:51200
    v_mfma_f32_16x16x32_bf16 v[204:207], v[84:87], v[32:35], v[204:207]
    ds_read_b128 v[108:111], v8 offset:53248
    v_mfma_f32_16x16x32_bf16 v[208:211], v[88:91], v[32:35], v[208:211]
    ds_read_b128 v[112:115], v8 offset:55296
    v_mfma_f32_16x16x32_bf16 v[212:215], v[84:87], v[36:39], v[212:215]
    ds_read_b128 v[116:119], v8 offset:57344
    v_mfma_f32_16x16x32_bf16 v[216:219], v[88:91], v[36:39], v[216:219]
    ds_read_b128 v[120:123], v8 offset:59392
    v_mfma_f32_16x16x32_bf16 v[220:223], v[84:87], v[40:43], v[220:223]
    ds_read_b128 v[124:127], v8 offset:61440
    v_mfma_f32_16x16x32_bf16 v[224:227], v[88:91], v[40:43], v[224:227]
    ds_read_b128 v[128:131], v8 offset:63488
    v_mfma_f32_16x16x32_bf16 v[228:231], v[84:87], v[44:47], v[228:231]
    ds_read_b64_tr_b16 v[172:173], v12 offset:24576
    v_mfma_f32_16x16x32_bf16 v[232:235], v[88:91], v[44:47], v[232:235]
    ds_read_b64_tr_b16 v[174:175], v12 offset:25600
    v_mfma_f32_16x16x32_bf16 v[236:239], v[84:87], v[48:51], v[236:239]
    ds_read_b64_tr_b16 v[176:177], v13 offset:24576
    v_mfma_f32_16x16x32_bf16 v[240:243], v[88:91], v[48:51], v[240:243]
    ds_read_b64_tr_b16 v[178:179], v13 offset:25600
    v_mfma_f32_16x16x32_bf16 v[180:183], v[92:95], v[52:55], v[180:183]
    ds_read_b128 v[132:135], v9 offset:49152
    v_mfma_f32_16x16x32_bf16 v[184:187], v[96:99], v[52:55], v[184:187]
    ds_read_b128 v[136:139], v9 offset:51200
    v_mfma_f32_16x16x32_bf16 v[188:191], v[92:95], v[56:59], v[188:191]
    ds_read_b128 v[140:143], v9 offset:53248
    v_mfma_f32_16x16x32_bf16 v[192:195], v[96:99], v[56:59], v[192:195]
    ds_read_b128 v[144:147], v9 offset:55296
    v_mfma_f32_16x16x32_bf16 v[196:199], v[92:95], v[60:63], v[196:199]
    ds_read_b128 v[148:151], v9 offset:57344
    v_mfma_f32_16x16x32_bf16 v[200:203], v[96:99], v[60:63], v[200:203]
    ds_read_b128 v[152:155], v9 offset:59392
    v_mfma_f32_16x16x32_bf16 v[204:207], v[92:95], v[64:67], v[204:207]
    ds_read_b128 v[156:159], v9 offset:61440
    v_mfma_f32_16x16x32_bf16 v[208:211], v[96:99], v[64:67], v[208:211]
    ds_read_b128 v[160:163], v9 offset:63488
    v_mfma_f32_16x16x32_bf16 v[212:215], v[92:95], v[68:71], v[212:215]
    v_mfma_f32_16x16x32_bf16 v[216:219], v[96:99], v[68:71], v[216:219]
    v_mfma_f32_16x16x32_bf16 v[220:223], v[92:95], v[72:75], v[220:223]
    v_mfma_f32_16x16x32_bf16 v[224:227], v[96:99], v[72:75], v[224:227]
    v_mfma_f32_16x16x32_bf16 v[228:231], v[92:95], v[76:79], v[228:231]
    v_mfma_f32_16x16x32_bf16 v[232:235], v[96:99], v[76:79], v[232:235]
    v_mfma_f32_16x16x32_bf16 v[236:239], v[92:95], v[80:83], v[236:239]
    v_mfma_f32_16x16x32_bf16 v[240:243], v[96:99], v[80:83], v[240:243]
    s_waitcnt lgkmcnt(0)
    s_barrier
    v_mfma_f32_16x16x32_bf16 v[180:183], v[164:167], v[100:103], v[180:183]
    ds_read_b64_tr_b16 v[84:85], v12 offset:32768
    v_mfma_f32_16x16x32_bf16 v[184:187], v[168:171], v[100:103], v[184:187]
    ds_read_b64_tr_b16 v[86:87], v12 offset:33792
    v_mfma_f32_16x16x32_bf16 v[188:191], v[164:167], v[104:107], v[188:191]
    ds_read_b64_tr_b16 v[88:89], v13 offset:32768
    v_mfma_f32_16x16x32_bf16 v[192:195], v[168:171], v[104:107], v[192:195]
    ds_read_b64_tr_b16 v[90:91], v13 offset:33792
    v_mfma_f32_16x16x32_bf16 v[196:199], v[164:167], v[108:111], v[196:199]
    ds_read_b128 v[20:23], v10 offset:0
    v_mfma_f32_16x16x32_bf16 v[200:203], v[168:171], v[108:111], v[200:203]
    ds_read_b128 v[24:27], v10 offset:2048
    v_mfma_f32_16x16x32_bf16 v[204:207], v[164:167], v[112:115], v[204:207]
    ds_read_b128 v[28:31], v10 offset:4096
    v_mfma_f32_16x16x32_bf16 v[208:211], v[168:171], v[112:115], v[208:211]
    ds_read_b128 v[32:35], v10 offset:6144
    v_mfma_f32_16x16x32_bf16 v[212:215], v[164:167], v[116:119], v[212:215]
    ds_read_b128 v[36:39], v10 offset:8192
    v_mfma_f32_16x16x32_bf16 v[216:219], v[168:171], v[116:119], v[216:219]
    ds_read_b128 v[40:43], v10 offset:10240
    v_mfma_f32_16x16x32_bf16 v[220:223], v[164:167], v[120:123], v[220:223]
    ds_read_b128 v[44:47], v10 offset:12288
    v_mfma_f32_16x16x32_bf16 v[224:227], v[168:171], v[120:123], v[224:227]
    ds_read_b128 v[48:51], v10 offset:14336
    v_mfma_f32_16x16x32_bf16 v[228:231], v[164:167], v[124:127], v[228:231]
    ds_read_b64_tr_b16 v[92:93], v12 offset:40960
    v_mfma_f32_16x16x32_bf16 v[232:235], v[168:171], v[124:127], v[232:235]
    ds_read_b64_tr_b16 v[94:95], v12 offset:41984
    v_mfma_f32_16x16x32_bf16 v[236:239], v[164:167], v[128:131], v[236:239]
    ds_read_b64_tr_b16 v[96:97], v13 offset:40960
    v_mfma_f32_16x16x32_bf16 v[240:243], v[168:171], v[128:131], v[240:243]
    ds_read_b64_tr_b16 v[98:99], v13 offset:41984
    v_mfma_f32_16x16x32_bf16 v[180:183], v[172:175], v[132:135], v[180:183]
    ds_read_b128 v[52:55], v11 offset:0
    v_mfma_f32_16x16x32_bf16 v[184:187], v[176:179], v[132:135], v[184:187]
    ds_read_b128 v[56:59], v11 offset:2048
    v_mfma_f32_16x16x32_bf16 v[188:191], v[172:175], v[136:139], v[188:191]
    ds_read_b128 v[60:63], v11 offset:4096
    v_mfma_f32_16x16x32_bf16 v[192:195], v[176:179], v[136:139], v[192:195]
    ds_read_b128 v[64:67], v11 offset:6144
    v_mfma_f32_16x16x32_bf16 v[196:199], v[172:175], v[140:143], v[196:199]
    ds_read_b128 v[68:71], v11 offset:8192
    v_mfma_f32_16x16x32_bf16 v[200:203], v[176:179], v[140:143], v[200:203]
    ds_read_b128 v[72:75], v11 offset:10240
    v_mfma_f32_16x16x32_bf16 v[204:207], v[172:175], v[144:147], v[204:207]
    ds_read_b128 v[76:79], v11 offset:12288
    v_mfma_f32_16x16x32_bf16 v[208:211], v[176:179], v[144:147], v[208:211]
    ds_read_b128 v[80:83], v11 offset:14336
    v_mfma_f32_16x16x32_bf16 v[212:215], v[172:175], v[148:151], v[212:215]
    v_mfma_f32_16x16x32_bf16 v[216:219], v[176:179], v[148:151], v[216:219]
    v_mfma_f32_16x16x32_bf16 v[220:223], v[172:175], v[152:155], v[220:223]
    v_mfma_f32_16x16x32_bf16 v[224:227], v[176:179], v[152:155], v[224:227]
    v_mfma_f32_16x16x32_bf16 v[228:231], v[172:175], v[156:159], v[228:231]
    v_mfma_f32_16x16x32_bf16 v[232:235], v[176:179], v[156:159], v[232:235]
    v_mfma_f32_16x16x32_bf16 v[236:239], v[172:175], v[160:163], v[236:239]
    v_mfma_f32_16x16x32_bf16 v[240:243], v[176:179], v[160:163], v[240:243]
    s_waitcnt lgkmcnt(0)
    s_barrier
    v_mfma_f32_16x16x32_bf16 v[180:183], v[84:87], v[20:23], v[180:183]
    ds_read_b64_tr_b16 v[164:165], v12 offset:49152
    v_mfma_f32_16x16x32_bf16 v[184:187], v[88:91], v[20:23], v[184:187]
    ds_read_b64_tr_b16 v[166:167], v12 offset:50176
    v_mfma_f32_16x16x32_bf16 v[188:191], v[84:87], v[24:27], v[188:191]
    ds_read_b64_tr_b16 v[168:169], v13 offset:49152
    v_mfma_f32_16x16x32_bf16 v[192:195], v[88:91], v[24:27], v[192:195]
    ds_read_b64_tr_b16 v[170:171], v13 offset:50176
    v_mfma_f32_16x16x32_bf16 v[196:199], v[84:87], v[28:31], v[196:199]
    ds_read_b128 v[100:103], v10 offset:16384
    v_mfma_f32_16x16x32_bf16 v[200:203], v[88:91], v[28:31], v[200:203]
    ds_read_b128 v[104:107], v10 offset:18432
    v_mfma_f32_16x16x32_bf16 v[204:207], v[84:87], v[32:35], v[204:207]
    ds_read_b128 v[108:111], v10 offset:20480
    v_mfma_f32_16x16x32_bf16 v[208:211], v[88:91], v[32:35], v[208:211]
    ds_read_b128 v[112:115], v10 offset:22528
    v_mfma_f32_16x16x32_bf16 v[212:215], v[84:87], v[36:39], v[212:215]
    ds_read_b128 v[116:119], v10 offset:24576
    v_mfma_f32_16x16x32_bf16 v[216:219], v[88:91], v[36:39], v[216:219]
    ds_read_b128 v[120:123], v10 offset:26624
    v_mfma_f32_16x16x32_bf16 v[220:223], v[84:87], v[40:43], v[220:223]
    ds_read_b128 v[124:127], v10 offset:28672
    v_mfma_f32_16x16x32_bf16 v[224:227], v[88:91], v[40:43], v[224:227]
    ds_read_b128 v[128:131], v10 offset:30720
    v_mfma_f32_16x16x32_bf16 v[228:231], v[84:87], v[44:47], v[228:231]
    ds_read_b64_tr_b16 v[172:173], v12 offset:57344
    v_mfma_f32_16x16x32_bf16 v[232:235], v[88:91], v[44:47], v[232:235]
    ds_read_b64_tr_b16 v[174:175], v12 offset:58368
    v_mfma_f32_16x16x32_bf16 v[236:239], v[84:87], v[48:51], v[236:239]
    ds_read_b64_tr_b16 v[176:177], v13 offset:57344
    v_mfma_f32_16x16x32_bf16 v[240:243], v[88:91], v[48:51], v[240:243]
    ds_read_b64_tr_b16 v[178:179], v13 offset:58368
    v_mfma_f32_16x16x32_bf16 v[180:183], v[92:95], v[52:55], v[180:183]
    ds_read_b128 v[132:135], v11 offset:16384
    v_mfma_f32_16x16x32_bf16 v[184:187], v[96:99], v[52:55], v[184:187]
    ds_read_b128 v[136:139], v11 offset:18432
    v_mfma_f32_16x16x32_bf16 v[188:191], v[92:95], v[56:59], v[188:191]
    ds_read_b128 v[140:143], v11 offset:20480
    v_mfma_f32_16x16x32_bf16 v[192:195], v[96:99], v[56:59], v[192:195]
    ds_read_b128 v[144:147], v11 offset:22528
    v_mfma_f32_16x16x32_bf16 v[196:199], v[92:95], v[60:63], v[196:199]
    ds_read_b128 v[148:151], v11 offset:24576
    v_mfma_f32_16x16x32_bf16 v[200:203], v[96:99], v[60:63], v[200:203]
    ds_read_b128 v[152:155], v11 offset:26624
    v_mfma_f32_16x16x32_bf16 v[204:207], v[92:95], v[64:67], v[204:207]
    ds_read_b128 v[156:159], v11 offset:28672
    v_mfma_f32_16x16x32_bf16 v[208:211], v[96:99], v[64:67], v[208:211]
    ds_read_b128 v[160:163], v11 offset:30720
    v_mfma_f32_16x16x32_bf16 v[212:215], v[92:95], v[68:71], v[212:215]
    v_mfma_f32_16x16x32_bf16 v[216:219], v[96:99], v[68:71], v[216:219]
    v_mfma_f32_16x16x32_bf16 v[220:223], v[92:95], v[72:75], v[220:223]
    v_mfma_f32_16x16x32_bf16 v[224:227], v[96:99], v[72:75], v[224:227]
    v_mfma_f32_16x16x32_bf16 v[228:231], v[92:95], v[76:79], v[228:231]
    v_mfma_f32_16x16x32_bf16 v[232:235], v[96:99], v[76:79], v[232:235]
    v_mfma_f32_16x16x32_bf16 v[236:239], v[92:95], v[80:83], v[236:239]
    v_mfma_f32_16x16x32_bf16 v[240:243], v[96:99], v[80:83], v[240:243]
    s_waitcnt lgkmcnt(0)
    s_barrier
    v_mfma_f32_16x16x32_bf16 v[180:183], v[164:167], v[100:103], v[180:183]
    ds_read_b64_tr_b16 v[84:85], v12 offset:0
    v_mfma_f32_16x16x32_bf16 v[184:187], v[168:171], v[100:103], v[184:187]
    ds_read_b64_tr_b16 v[86:87], v12 offset:1024
    v_mfma_f32_16x16x32_bf16 v[188:191], v[164:167], v[104:107], v[188:191]
    ds_read_b64_tr_b16 v[88:89], v13 offset:0
    v_mfma_f32_16x16x32_bf16 v[192:195], v[168:171], v[104:107], v[192:195]
    ds_read_b64_tr_b16 v[90:91], v13 offset:1024
    v_mfma_f32_16x16x32_bf16 v[196:199], v[164:167], v[108:111], v[196:199]
    ds_read_b128 v[20:23], v8 offset:0
    v_mfma_f32_16x16x32_bf16 v[200:203], v[168:171], v[108:111], v[200:203]
    ds_read_b128 v[24:27], v8 offset:2048
    v_mfma_f32_16x16x32_bf16 v[204:207], v[164:167], v[112:115], v[204:207]
    ds_read_b128 v[28:31], v8 offset:4096
    v_mfma_f32_16x16x32_bf16 v[208:211], v[168:171], v[112:115], v[208:211]
    ds_read_b128 v[32:35], v8 offset:6144
    v_mfma_f32_16x16x32_bf16 v[212:215], v[164:167], v[116:119], v[212:215]
    ds_read_b128 v[36:39], v8 offset:8192
    v_mfma_f32_16x16x32_bf16 v[216:219], v[168:171], v[116:119], v[216:219]
    ds_read_b128 v[40:43], v8 offset:10240
    v_mfma_f32_16x16x32_bf16 v[220:223], v[164:167], v[120:123], v[220:223]
    ds_read_b128 v[44:47], v8 offset:12288
    v_mfma_f32_16x16x32_bf16 v[224:227], v[168:171], v[120:123], v[224:227]
    ds_read_b128 v[48:51], v8 offset:14336
    v_mfma_f32_16x16x32_bf16 v[228:231], v[164:167], v[124:127], v[228:231]
    ds_read_b64_tr_b16 v[92:93], v12 offset:8192
    v_mfma_f32_16x16x32_bf16 v[232:235], v[168:171], v[124:127], v[232:235]
    ds_read_b64_tr_b16 v[94:95], v12 offset:9216
    v_mfma_f32_16x16x32_bf16 v[236:239], v[164:167], v[128:131], v[236:239]
    ds_read_b64_tr_b16 v[96:97], v13 offset:8192
    v_mfma_f32_16x16x32_bf16 v[240:243], v[168:171], v[128:131], v[240:243]
    ds_read_b64_tr_b16 v[98:99], v13 offset:9216
    v_mfma_f32_16x16x32_bf16 v[180:183], v[172:175], v[132:135], v[180:183]
    ds_read_b128 v[52:55], v9 offset:0
    v_mfma_f32_16x16x32_bf16 v[184:187], v[176:179], v[132:135], v[184:187]
    ds_read_b128 v[56:59], v9 offset:2048
    v_mfma_f32_16x16x32_bf16 v[188:191], v[172:175], v[136:139], v[188:191]
    ds_read_b128 v[60:63], v9 offset:4096
    v_mfma_f32_16x16x32_bf16 v[192:195], v[176:179], v[136:139], v[192:195]
    ds_read_b128 v[64:67], v9 offset:6144
    v_mfma_f32_16x16x32_bf16 v[196:199], v[172:175], v[140:143], v[196:199]
    ds_read_b128 v[68:71], v9 offset:8192
    v_mfma_f32_16x16x32_bf16 v[200:203], v[176:179], v[140:143], v[200:203]
    ds_read_b128 v[72:75], v9 offset:10240
    v_mfma_f32_16x16x32_bf16 v[204:207], v[172:175], v[144:147], v[204:207]
    ds_read_b128 v[76:79], v9 offset:12288
    v_mfma_f32_16x16x32_bf16 v[208:211], v[176:179], v[144:147], v[208:211]
    ds_read_b128 v[80:83], v9 offset:14336
    v_mfma_f32_16x16x32_bf16 v[212:215], v[172:175], v[148:151], v[212:215]
    v_mfma_f32_16x16x32_bf16 v[216:219], v[176:179], v[148:151], v[216:219]
    v_mfma_f32_16x16x32_bf16 v[220:223], v[172:175], v[152:155], v[220:223]
    v_mfma_f32_16x16x32_bf16 v[224:227], v[176:179], v[152:155], v[224:227]
    v_mfma_f32_16x16x32_bf16 v[228:231], v[172:175], v[156:159], v[228:231]
    v_mfma_f32_16x16x32_bf16 v[232:235], v[176:179], v[156:159], v[232:235]
    v_mfma_f32_16x16x32_bf16 v[236:239], v[172:175], v[160:163], v[236:239]
    v_mfma_f32_16x16x32_bf16 v[240:243], v[176:179], v[160:163], v[240:243]
    s_waitcnt lgkmcnt(0)
    s_barrier
    v_mfma_f32_16x16x32_bf16 v[180:183], v[84:87], v[20:23], v[180:183]
    ds_read_b64_tr_b16 v[164:165], v12 offset:16384
    v_mfma_f32_16x16x32_bf16 v[184:187], v[88:91], v[20:23], v[184:187]
    ds_read_b64_tr_b16 v[166:167], v12 offset:17408
    v_mfma_f32_16x16x32_bf16 v[188:191], v[84:87], v[24:27], v[188:191]
    ds_read_b64_tr_b16 v[168:169], v13 offset:16384
    v_mfma_f32_16x16x32_bf16 v[192:195], v[88:91], v[24:27], v[192:195]
    ds_read_b64_tr_b16 v[170:171], v13 offset:17408
    v_mfma_f32_16x16x32_bf16 v[196:199], v[84:87], v[28:31], v[196:199]
    ds_read_b128 v[100:103], v8 offset:16384
    v_mfma_f32_16x16x32_bf16 v[200:203], v[88:91], v[28:31], v[200:203]
    ds_read_b128 v[104:107], v8 offset:18432
    v_mfma_f32_16x16x32_bf16 v[204:207], v[84:87], v[32:35], v[204:207]
    ds_read_b128 v[108:111], v8 offset:20480
    v_mfma_f32_16x16x32_bf16 v[208:211], v[88:91], v[32:35], v[208:211]
    ds_read_b128 v[112:115], v8 offset:22528
    v_mfma_f32_16x16x32_bf16 v[212:215], v[84:87], v[36:39], v[212:215]
    ds_read_b128 v[116:119], v8 offset:24576
    v_mfma_f32_16x16x32_bf16 v[216:219], v[88:91], v[36:39], v[216:219]
    ds_read_b128 v[120:123], v8 offset:26624
    v_mfma_f32_16x16x32_bf16 v[220:223], v[84:87], v[40:43], v[220:223]
    ds_read_b128 v[124:127], v8 offset:28672
    v_mfma_f32_16x16x32_bf16 v[224:227], v[88:91], v[40:43], v[224:227]
    ds_read_b128 v[128:131], v8 offset:30720
    v_mfma_f32_16x16x32_bf16 v[228:231], v[84:87], v[44:47], v[228:231]
    ds_read_b64_tr_b16 v[172:173], v12 offset:24576
    v_mfma_f32_16x16x32_bf16 v[232:235], v[88:91], v[44:47], v[232:235]
    ds_read_b64_tr_b16 v[174:175], v12 offset:25600
    v_mfma_f32_16x16x32_bf16 v[236:239], v[84:87], v[48:51], v[236:239]
    ds_read_b64_tr_b16 v[176:177], v13 offset:24576
    v_mfma_f32_16x16x32_bf16 v[240:243], v[88:91], v[48:51], v[240:243]
    ds_read_b64_tr_b16 v[178:179], v13 offset:25600
    v_mfma_f32_16x16x32_bf16 v[180:183], v[92:95], v[52:55], v[180:183]
    ds_read_b128 v[132:135], v9 offset:16384
    v_mfma_f32_16x16x32_bf16 v[184:187], v[96:99], v[52:55], v[184:187]
    ds_read_b128 v[136:139], v9 offset:18432
    v_mfma_f32_16x16x32_bf16 v[188:191], v[92:95], v[56:59], v[188:191]
    ds_read_b128 v[140:143], v9 offset:20480
    v_mfma_f32_16x16x32_bf16 v[192:195], v[96:99], v[56:59], v[192:195]
    ds_read_b128 v[144:147], v9 offset:22528
    v_mfma_f32_16x16x32_bf16 v[196:199], v[92:95], v[60:63], v[196:199]
    ds_read_b128 v[148:151], v9 offset:24576
    v_mfma_f32_16x16x32_bf16 v[200:203], v[96:99], v[60:63], v[200:203]
    ds_read_b128 v[152:155], v9 offset:26624
    v_mfma_f32_16x16x32_bf16 v[204:207], v[92:95], v[64:67], v[204:207]
    ds_read_b128 v[156:159], v9 offset:28672
    v_mfma_f32_16x16x32_bf16 v[208:211], v[96:99], v[64:67], v[208:211]
    ds_read_b128 v[160:163], v9 offset:30720
    v_mfma_f32_16x16x32_bf16 v[212:215], v[92:95], v[68:71], v[212:215]
    v_mfma_f32_16x16x32_bf16 v[216:219], v[96:99], v[68:71], v[216:219]
    v_mfma_f32_16x16x32_bf16 v[220:223], v[92:95], v[72:75], v[220:223]
    v_mfma_f32_16x16x32_bf16 v[224:227], v[96:99], v[72:75], v[224:227]
    v_mfma_f32_16x16x32_bf16 v[228:231], v[92:95], v[76:79], v[228:231]
    v_mfma_f32_16x16x32_bf16 v[232:235], v[96:99], v[76:79], v[232:235]
    v_mfma_f32_16x16x32_bf16 v[236:239], v[92:95], v[80:83], v[236:239]
    v_mfma_f32_16x16x32_bf16 v[240:243], v[96:99], v[80:83], v[240:243]
    s_waitcnt lgkmcnt(0)
    s_barrier
    v_mfma_f32_16x16x32_bf16 v[180:183], v[164:167], v[100:103], v[180:183]
    ds_read_b64_tr_b16 v[84:85], v12 offset:32768
    v_mfma_f32_16x16x32_bf16 v[184:187], v[168:171], v[100:103], v[184:187]
    ds_read_b64_tr_b16 v[86:87], v12 offset:33792
    v_mfma_f32_16x16x32_bf16 v[188:191], v[164:167], v[104:107], v[188:191]
    ds_read_b64_tr_b16 v[88:89], v13 offset:32768
    v_mfma_f32_16x16x32_bf16 v[192:195], v[168:171], v[104:107], v[192:195]
    ds_read_b64_tr_b16 v[90:91], v13 offset:33792
    v_mfma_f32_16x16x32_bf16 v[196:199], v[164:167], v[108:111], v[196:199]
    ds_read_b128 v[20:23], v8 offset:32768
    v_mfma_f32_16x16x32_bf16 v[200:203], v[168:171], v[108:111], v[200:203]
    ds_read_b128 v[24:27], v8 offset:34816
    v_mfma_f32_16x16x32_bf16 v[204:207], v[164:167], v[112:115], v[204:207]
    ds_read_b128 v[28:31], v8 offset:36864
    v_mfma_f32_16x16x32_bf16 v[208:211], v[168:171], v[112:115], v[208:211]
    ds_read_b128 v[32:35], v8 offset:38912
    v_mfma_f32_16x16x32_bf16 v[212:215], v[164:167], v[116:119], v[212:215]
    ds_read_b128 v[36:39], v8 offset:40960
    v_mfma_f32_16x16x32_bf16 v[216:219], v[168:171], v[116:119], v[216:219]
    ds_read_b128 v[40:43], v8 offset:43008
    v_mfma_f32_16x16x32_bf16 v[220:223], v[164:167], v[120:123], v[220:223]
    ds_read_b128 v[44:47], v8 offset:45056
    v_mfma_f32_16x16x32_bf16 v[224:227], v[168:171], v[120:123], v[224:227]
    ds_read_b128 v[48:51], v8 offset:47104
    v_mfma_f32_16x16x32_bf16 v[228:231], v[164:167], v[124:127], v[228:231]
    ds_read_b64_tr_b16 v[92:93], v12 offset:40960
    v_mfma_f32_16x16x32_bf16 v[232:235], v[168:171], v[124:127], v[232:235]
    ds_read_b64_tr_b16 v[94:95], v12 offset:41984
    v_mfma_f32_16x16x32_bf16 v[236:239], v[164:167], v[128:131], v[236:239]
    ds_read_b64_tr_b16 v[96:97], v13 offset:40960
    v_mfma_f32_16x16x32_bf16 v[240:243], v[168:171], v[128:131], v[240:243]
    ds_read_b64_tr_b16 v[98:99], v13 offset:41984
    v_mfma_f32_16x16x32_bf16 v[180:183], v[172:175], v[132:135], v[180:183]
    ds_read_b128 v[52:55], v9 offset:32768
    v_mfma_f32_16x16x32_bf16 v[184:187], v[176:179], v[132:135], v[184:187]
    ds_read_b128 v[56:59], v9 offset:34816
    v_mfma_f32_16x16x32_bf16 v[188:191], v[172:175], v[136:139], v[188:191]
    ds_read_b128 v[60:63], v9 offset:36864
    v_mfma_f32_16x16x32_bf16 v[192:195], v[176:179], v[136:139], v[192:195]
    ds_read_b128 v[64:67], v9 offset:38912
    v_mfma_f32_16x16x32_bf16 v[196:199], v[172:175], v[140:143], v[196:199]
    ds_read_b128 v[68:71], v9 offset:40960
    v_mfma_f32_16x16x32_bf16 v[200:203], v[176:179], v[140:143], v[200:203]
    ds_read_b128 v[72:75], v9 offset:43008
    v_mfma_f32_16x16x32_bf16 v[204:207], v[172:175], v[144:147], v[204:207]
    ds_read_b128 v[76:79], v9 offset:45056
    v_mfma_f32_16x16x32_bf16 v[208:211], v[176:179], v[144:147], v[208:211]
    ds_read_b128 v[80:83], v9 offset:47104
    v_mfma_f32_16x16x32_bf16 v[212:215], v[172:175], v[148:151], v[212:215]
    v_mfma_f32_16x16x32_bf16 v[216:219], v[176:179], v[148:151], v[216:219]
    v_mfma_f32_16x16x32_bf16 v[220:223], v[172:175], v[152:155], v[220:223]
    v_mfma_f32_16x16x32_bf16 v[224:227], v[176:179], v[152:155], v[224:227]
    v_mfma_f32_16x16x32_bf16 v[228:231], v[172:175], v[156:159], v[228:231]
    v_mfma_f32_16x16x32_bf16 v[232:235], v[176:179], v[156:159], v[232:235]
    v_mfma_f32_16x16x32_bf16 v[236:239], v[172:175], v[160:163], v[236:239]
    v_mfma_f32_16x16x32_bf16 v[240:243], v[176:179], v[160:163], v[240:243]
    s_waitcnt lgkmcnt(0)
    s_barrier
    v_mfma_f32_16x16x32_bf16 v[180:183], v[84:87], v[20:23], v[180:183]
    ds_read_b64_tr_b16 v[164:165], v12 offset:49152
    v_mfma_f32_16x16x32_bf16 v[184:187], v[88:91], v[20:23], v[184:187]
    ds_read_b64_tr_b16 v[166:167], v12 offset:50176
    v_mfma_f32_16x16x32_bf16 v[188:191], v[84:87], v[24:27], v[188:191]
    ds_read_b64_tr_b16 v[168:169], v13 offset:49152
    v_mfma_f32_16x16x32_bf16 v[192:195], v[88:91], v[24:27], v[192:195]
    ds_read_b64_tr_b16 v[170:171], v13 offset:50176
    v_mfma_f32_16x16x32_bf16 v[196:199], v[84:87], v[28:31], v[196:199]
    ds_read_b128 v[100:103], v8 offset:49152
    v_mfma_f32_16x16x32_bf16 v[200:203], v[88:91], v[28:31], v[200:203]
    ds_read_b128 v[104:107], v8 offset:51200
    v_mfma_f32_16x16x32_bf16 v[204:207], v[84:87], v[32:35], v[204:207]
    ds_read_b128 v[108:111], v8 offset:53248
    v_mfma_f32_16x16x32_bf16 v[208:211], v[88:91], v[32:35], v[208:211]
    ds_read_b128 v[112:115], v8 offset:55296
    v_mfma_f32_16x16x32_bf16 v[212:215], v[84:87], v[36:39], v[212:215]
    ds_read_b128 v[116:119], v8 offset:57344
    v_mfma_f32_16x16x32_bf16 v[216:219], v[88:91], v[36:39], v[216:219]
    ds_read_b128 v[120:123], v8 offset:59392
    v_mfma_f32_16x16x32_bf16 v[220:223], v[84:87], v[40:43], v[220:223]
    ds_read_b128 v[124:127], v8 offset:61440
    v_mfma_f32_16x16x32_bf16 v[224:227], v[88:91], v[40:43], v[224:227]
    ds_read_b128 v[128:131], v8 offset:63488
    v_mfma_f32_16x16x32_bf16 v[228:231], v[84:87], v[44:47], v[228:231]
    ds_read_b64_tr_b16 v[172:173], v12 offset:57344
    v_mfma_f32_16x16x32_bf16 v[232:235], v[88:91], v[44:47], v[232:235]
    ds_read_b64_tr_b16 v[174:175], v12 offset:58368
    v_mfma_f32_16x16x32_bf16 v[236:239], v[84:87], v[48:51], v[236:239]
    ds_read_b64_tr_b16 v[176:177], v13 offset:57344
    v_mfma_f32_16x16x32_bf16 v[240:243], v[88:91], v[48:51], v[240:243]
    ds_read_b64_tr_b16 v[178:179], v13 offset:58368
    v_mfma_f32_16x16x32_bf16 v[180:183], v[92:95], v[52:55], v[180:183]
    ds_read_b128 v[132:135], v9 offset:49152
    v_mfma_f32_16x16x32_bf16 v[184:187], v[96:99], v[52:55], v[184:187]
    ds_read_b128 v[136:139], v9 offset:51200
    v_mfma_f32_16x16x32_bf16 v[188:191], v[92:95], v[56:59], v[188:191]
    ds_read_b128 v[140:143], v9 offset:53248
    v_mfma_f32_16x16x32_bf16 v[192:195], v[96:99], v[56:59], v[192:195]
    ds_read_b128 v[144:147], v9 offset:55296
    v_mfma_f32_16x16x32_bf16 v[196:199], v[92:95], v[60:63], v[196:199]
    ds_read_b128 v[148:151], v9 offset:57344
    v_mfma_f32_16x16x32_bf16 v[200:203], v[96:99], v[60:63], v[200:203]
    ds_read_b128 v[152:155], v9 offset:59392
    v_mfma_f32_16x16x32_bf16 v[204:207], v[92:95], v[64:67], v[204:207]
    ds_read_b128 v[156:159], v9 offset:61440
    v_mfma_f32_16x16x32_bf16 v[208:211], v[96:99], v[64:67], v[208:211]
    ds_read_b128 v[160:163], v9 offset:63488
    v_mfma_f32_16x16x32_bf16 v[212:215], v[92:95], v[68:71], v[212:215]
    v_mfma_f32_16x16x32_bf16 v[216:219], v[96:99], v[68:71], v[216:219]
    v_mfma_f32_16x16x32_bf16 v[220:223], v[92:95], v[72:75], v[220:223]
    v_mfma_f32_16x16x32_bf16 v[224:227], v[96:99], v[72:75], v[224:227]
    v_mfma_f32_16x16x32_bf16 v[228:231], v[92:95], v[76:79], v[228:231]
    v_mfma_f32_16x16x32_bf16 v[232:235], v[96:99], v[76:79], v[232:235]
    v_mfma_f32_16x16x32_bf16 v[236:239], v[92:95], v[80:83], v[236:239]
    v_mfma_f32_16x16x32_bf16 v[240:243], v[96:99], v[80:83], v[240:243]
    s_waitcnt lgkmcnt(0)
    s_barrier
    v_mfma_f32_16x16x32_bf16 v[180:183], v[164:167], v[100:103], v[180:183]
    ds_read_b64_tr_b16 v[84:85], v12 offset:0
    v_mfma_f32_16x16x32_bf16 v[184:187], v[168:171], v[100:103], v[184:187]
    ds_read_b64_tr_b16 v[86:87], v12 offset:1024
    v_mfma_f32_16x16x32_bf16 v[188:191], v[164:167], v[104:107], v[188:191]
    ds_read_b64_tr_b16 v[88:89], v13 offset:0
    v_mfma_f32_16x16x32_bf16 v[192:195], v[168:171], v[104:107], v[192:195]
    ds_read_b64_tr_b16 v[90:91], v13 offset:1024
    v_mfma_f32_16x16x32_bf16 v[196:199], v[164:167], v[108:111], v[196:199]
    ds_read_b128 v[20:23], v10 offset:0
    v_mfma_f32_16x16x32_bf16 v[200:203], v[168:171], v[108:111], v[200:203]
    ds_read_b128 v[24:27], v10 offset:2048
    v_mfma_f32_16x16x32_bf16 v[204:207], v[164:167], v[112:115], v[204:207]
    ds_read_b128 v[28:31], v10 offset:4096
    v_mfma_f32_16x16x32_bf16 v[208:211], v[168:171], v[112:115], v[208:211]
    ds_read_b128 v[32:35], v10 offset:6144
    v_mfma_f32_16x16x32_bf16 v[212:215], v[164:167], v[116:119], v[212:215]
    ds_read_b128 v[36:39], v10 offset:8192
    v_mfma_f32_16x16x32_bf16 v[216:219], v[168:171], v[116:119], v[216:219]
    ds_read_b128 v[40:43], v10 offset:10240
    v_mfma_f32_16x16x32_bf16 v[220:223], v[164:167], v[120:123], v[220:223]
    ds_read_b128 v[44:47], v10 offset:12288
    v_mfma_f32_16x16x32_bf16 v[224:227], v[168:171], v[120:123], v[224:227]
    ds_read_b128 v[48:51], v10 offset:14336
    v_mfma_f32_16x16x32_bf16 v[228:231], v[164:167], v[124:127], v[228:231]
    ds_read_b64_tr_b16 v[92:93], v12 offset:8192
    v_mfma_f32_16x16x32_bf16 v[232:235], v[168:171], v[124:127], v[232:235]
    ds_read_b64_tr_b16 v[94:95], v12 offset:9216
    v_mfma_f32_16x16x32_bf16 v[236:239], v[164:167], v[128:131], v[236:239]
    ds_read_b64_tr_b16 v[96:97], v13 offset:8192
    v_mfma_f32_16x16x32_bf16 v[240:243], v[168:171], v[128:131], v[240:243]
    ds_read_b64_tr_b16 v[98:99], v13 offset:9216
    v_mfma_f32_16x16x32_bf16 v[180:183], v[172:175], v[132:135], v[180:183]
    ds_read_b128 v[52:55], v11 offset:0
    v_mfma_f32_16x16x32_bf16 v[184:187], v[176:179], v[132:135], v[184:187]
    ds_read_b128 v[56:59], v11 offset:2048
    v_mfma_f32_16x16x32_bf16 v[188:191], v[172:175], v[136:139], v[188:191]
    ds_read_b128 v[60:63], v11 offset:4096
    v_mfma_f32_16x16x32_bf16 v[192:195], v[176:179], v[136:139], v[192:195]
    ds_read_b128 v[64:67], v11 offset:6144
    v_mfma_f32_16x16x32_bf16 v[196:199], v[172:175], v[140:143], v[196:199]
    ds_read_b128 v[68:71], v11 offset:8192
    v_mfma_f32_16x16x32_bf16 v[200:203], v[176:179], v[140:143], v[200:203]
    ds_read_b128 v[72:75], v11 offset:10240
    v_mfma_f32_16x16x32_bf16 v[204:207], v[172:175], v[144:147], v[204:207]
    ds_read_b128 v[76:79], v11 offset:12288
    v_mfma_f32_16x16x32_bf16 v[208:211], v[176:179], v[144:147], v[208:211]
    ds_read_b128 v[80:83], v11 offset:14336
    v_mfma_f32_16x16x32_bf16 v[212:215], v[172:175], v[148:151], v[212:215]
    v_mfma_f32_16x16x32_bf16 v[216:219], v[176:179], v[148:151], v[216:219]
    v_mfma_f32_16x16x32_bf16 v[220:223], v[172:175], v[152:155], v[220:223]
    v_mfma_f32_16x16x32_bf16 v[224:227], v[176:179], v[152:155], v[224:227]
    v_mfma_f32_16x16x32_bf16 v[228:231], v[172:175], v[156:159], v[228:231]
    v_mfma_f32_16x16x32_bf16 v[232:235], v[176:179], v[156:159], v[232:235]
    v_mfma_f32_16x16x32_bf16 v[236:239], v[172:175], v[160:163], v[236:239]
    v_mfma_f32_16x16x32_bf16 v[240:243], v[176:179], v[160:163], v[240:243]
    s_waitcnt lgkmcnt(0)
    s_barrier
    v_mfma_f32_16x16x32_bf16 v[180:183], v[84:87], v[20:23], v[180:183]
    ds_read_b64_tr_b16 v[164:165], v12 offset:16384
    v_mfma_f32_16x16x32_bf16 v[184:187], v[88:91], v[20:23], v[184:187]
    ds_read_b64_tr_b16 v[166:167], v12 offset:17408
    v_mfma_f32_16x16x32_bf16 v[188:191], v[84:87], v[24:27], v[188:191]
    ds_read_b64_tr_b16 v[168:169], v13 offset:16384
    v_mfma_f32_16x16x32_bf16 v[192:195], v[88:91], v[24:27], v[192:195]
    ds_read_b64_tr_b16 v[170:171], v13 offset:17408
    v_mfma_f32_16x16x32_bf16 v[196:199], v[84:87], v[28:31], v[196:199]
    ds_read_b128 v[100:103], v10 offset:16384
    v_mfma_f32_16x16x32_bf16 v[200:203], v[88:91], v[28:31], v[200:203]
    ds_read_b128 v[104:107], v10 offset:18432
    v_mfma_f32_16x16x32_bf16 v[204:207], v[84:87], v[32:35], v[204:207]
    ds_read_b128 v[108:111], v10 offset:20480
    v_mfma_f32_16x16x32_bf16 v[208:211], v[88:91], v[32:35], v[208:211]
    ds_read_b128 v[112:115], v10 offset:22528
    v_mfma_f32_16x16x32_bf16 v[212:215], v[84:87], v[36:39], v[212:215]
    ds_read_b128 v[116:119], v10 offset:24576
    v_mfma_f32_16x16x32_bf16 v[216:219], v[88:91], v[36:39], v[216:219]
    ds_read_b128 v[120:123], v10 offset:26624
    v_mfma_f32_16x16x32_bf16 v[220:223], v[84:87], v[40:43], v[220:223]
    ds_read_b128 v[124:127], v10 offset:28672
    v_mfma_f32_16x16x32_bf16 v[224:227], v[88:91], v[40:43], v[224:227]
    ds_read_b128 v[128:131], v10 offset:30720
    v_mfma_f32_16x16x32_bf16 v[228:231], v[84:87], v[44:47], v[228:231]
    ds_read_b64_tr_b16 v[172:173], v12 offset:24576
    v_mfma_f32_16x16x32_bf16 v[232:235], v[88:91], v[44:47], v[232:235]
    ds_read_b64_tr_b16 v[174:175], v12 offset:25600
    v_mfma_f32_16x16x32_bf16 v[236:239], v[84:87], v[48:51], v[236:239]
    ds_read_b64_tr_b16 v[176:177], v13 offset:24576
    v_mfma_f32_16x16x32_bf16 v[240:243], v[88:91], v[48:51], v[240:243]
    ds_read_b64_tr_b16 v[178:179], v13 offset:25600
    v_mfma_f32_16x16x32_bf16 v[180:183], v[92:95], v[52:55], v[180:183]
    ds_read_b128 v[132:135], v11 offset:16384
    v_mfma_f32_16x16x32_bf16 v[184:187], v[96:99], v[52:55], v[184:187]
    ds_read_b128 v[136:139], v11 offset:18432
    v_mfma_f32_16x16x32_bf16 v[188:191], v[92:95], v[56:59], v[188:191]
    ds_read_b128 v[140:143], v11 offset:20480
    v_mfma_f32_16x16x32_bf16 v[192:195], v[96:99], v[56:59], v[192:195]
    ds_read_b128 v[144:147], v11 offset:22528
    v_mfma_f32_16x16x32_bf16 v[196:199], v[92:95], v[60:63], v[196:199]
    ds_read_b128 v[148:151], v11 offset:24576
    v_mfma_f32_16x16x32_bf16 v[200:203], v[96:99], v[60:63], v[200:203]
    ds_read_b128 v[152:155], v11 offset:26624
    v_mfma_f32_16x16x32_bf16 v[204:207], v[92:95], v[64:67], v[204:207]
    ds_read_b128 v[156:159], v11 offset:28672
    v_mfma_f32_16x16x32_bf16 v[208:211], v[96:99], v[64:67], v[208:211]
    ds_read_b128 v[160:163], v11 offset:30720
    v_mfma_f32_16x16x32_bf16 v[212:215], v[92:95], v[68:71], v[212:215]
    v_mfma_f32_16x16x32_bf16 v[216:219], v[96:99], v[68:71], v[216:219]
    v_mfma_f32_16x16x32_bf16 v[220:223], v[92:95], v[72:75], v[220:223]
    v_mfma_f32_16x16x32_bf16 v[224:227], v[96:99], v[72:75], v[224:227]
    v_mfma_f32_16x16x32_bf16 v[228:231], v[92:95], v[76:79], v[228:231]
    v_mfma_f32_16x16x32_bf16 v[232:235], v[96:99], v[76:79], v[232:235]
    v_mfma_f32_16x16x32_bf16 v[236:239], v[92:95], v[80:83], v[236:239]
    v_mfma_f32_16x16x32_bf16 v[240:243], v[96:99], v[80:83], v[240:243]
    s_waitcnt lgkmcnt(0)
    s_barrier
    v_mfma_f32_16x16x32_bf16 v[180:183], v[164:167], v[100:103], v[180:183]
    ds_read_b64_tr_b16 v[84:85], v12 offset:32768
    v_mfma_f32_16x16x32_bf16 v[184:187], v[168:171], v[100:103], v[184:187]
    ds_read_b64_tr_b16 v[86:87], v12 offset:33792
    v_mfma_f32_16x16x32_bf16 v[188:191], v[164:167], v[104:107], v[188:191]
    ds_read_b64_tr_b16 v[88:89], v13 offset:32768
    v_mfma_f32_16x16x32_bf16 v[192:195], v[168:171], v[104:107], v[192:195]
    ds_read_b64_tr_b16 v[90:91], v13 offset:33792
    v_mfma_f32_16x16x32_bf16 v[196:199], v[164:167], v[108:111], v[196:199]
    ds_read_b128 v[20:23], v8 offset:0
    v_mfma_f32_16x16x32_bf16 v[200:203], v[168:171], v[108:111], v[200:203]
    ds_read_b128 v[24:27], v8 offset:2048
    v_mfma_f32_16x16x32_bf16 v[204:207], v[164:167], v[112:115], v[204:207]
    ds_read_b128 v[28:31], v8 offset:4096
    v_mfma_f32_16x16x32_bf16 v[208:211], v[168:171], v[112:115], v[208:211]
    ds_read_b128 v[32:35], v8 offset:6144
    v_mfma_f32_16x16x32_bf16 v[212:215], v[164:167], v[116:119], v[212:215]
    ds_read_b128 v[36:39], v8 offset:8192
    v_mfma_f32_16x16x32_bf16 v[216:219], v[168:171], v[116:119], v[216:219]
    ds_read_b128 v[40:43], v8 offset:10240
    v_mfma_f32_16x16x32_bf16 v[220:223], v[164:167], v[120:123], v[220:223]
    ds_read_b128 v[44:47], v8 offset:12288
    v_mfma_f32_16x16x32_bf16 v[224:227], v[168:171], v[120:123], v[224:227]
    ds_read_b128 v[48:51], v8 offset:14336
    v_mfma_f32_16x16x32_bf16 v[228:231], v[164:167], v[124:127], v[228:231]
    ds_read_b64_tr_b16 v[92:93], v12 offset:40960
    v_mfma_f32_16x16x32_bf16 v[232:235], v[168:171], v[124:127], v[232:235]
    ds_read_b64_tr_b16 v[94:95], v12 offset:41984
    v_mfma_f32_16x16x32_bf16 v[236:239], v[164:167], v[128:131], v[236:239]
    ds_read_b64_tr_b16 v[96:97], v13 offset:40960
    v_mfma_f32_16x16x32_bf16 v[240:243], v[168:171], v[128:131], v[240:243]
    ds_read_b64_tr_b16 v[98:99], v13 offset:41984
    v_mfma_f32_16x16x32_bf16 v[180:183], v[172:175], v[132:135], v[180:183]
    ds_read_b128 v[52:55], v9 offset:0
    v_mfma_f32_16x16x32_bf16 v[184:187], v[176:179], v[132:135], v[184:187]
    ds_read_b128 v[56:59], v9 offset:2048
    v_mfma_f32_16x16x32_bf16 v[188:191], v[172:175], v[136:139], v[188:191]
    ds_read_b128 v[60:63], v9 offset:4096
    v_mfma_f32_16x16x32_bf16 v[192:195], v[176:179], v[136:139], v[192:195]
    ds_read_b128 v[64:67], v9 offset:6144
    v_mfma_f32_16x16x32_bf16 v[196:199], v[172:175], v[140:143], v[196:199]
    ds_read_b128 v[68:71], v9 offset:8192
    v_mfma_f32_16x16x32_bf16 v[200:203], v[176:179], v[140:143], v[200:203]
    ds_read_b128 v[72:75], v9 offset:10240
    v_mfma_f32_16x16x32_bf16 v[204:207], v[172:175], v[144:147], v[204:207]
    ds_read_b128 v[76:79], v9 offset:12288
    v_mfma_f32_16x16x32_bf16 v[208:211], v[176:179], v[144:147], v[208:211]
    ds_read_b128 v[80:83], v9 offset:14336
    v_mfma_f32_16x16x32_bf16 v[212:215], v[172:175], v[148:151], v[212:215]
    v_mfma_f32_16x16x32_bf16 v[216:219], v[176:179], v[148:151], v[216:219]
    v_mfma_f32_16x16x32_bf16 v[220:223], v[172:175], v[152:155], v[220:223]
    v_mfma_f32_16x16x32_bf16 v[224:227], v[176:179], v[152:155], v[224:227]
    v_mfma_f32_16x16x32_bf16 v[228:231], v[172:175], v[156:159], v[228:231]
    v_mfma_f32_16x16x32_bf16 v[232:235], v[176:179], v[156:159], v[232:235]
    v_mfma_f32_16x16x32_bf16 v[236:239], v[172:175], v[160:163], v[236:239]
    v_mfma_f32_16x16x32_bf16 v[240:243], v[176:179], v[160:163], v[240:243]
    s_waitcnt lgkmcnt(0)
    s_barrier
    v_mfma_f32_16x16x32_bf16 v[180:183], v[84:87], v[20:23], v[180:183]
    ds_read_b64_tr_b16 v[164:165], v12 offset:49152
    v_mfma_f32_16x16x32_bf16 v[184:187], v[88:91], v[20:23], v[184:187]
    ds_read_b64_tr_b16 v[166:167], v12 offset:50176
    v_mfma_f32_16x16x32_bf16 v[188:191], v[84:87], v[24:27], v[188:191]
    ds_read_b64_tr_b16 v[168:169], v13 offset:49152
    v_mfma_f32_16x16x32_bf16 v[192:195], v[88:91], v[24:27], v[192:195]
    ds_read_b64_tr_b16 v[170:171], v13 offset:50176
    v_mfma_f32_16x16x32_bf16 v[196:199], v[84:87], v[28:31], v[196:199]
    ds_read_b128 v[100:103], v8 offset:16384
    v_mfma_f32_16x16x32_bf16 v[200:203], v[88:91], v[28:31], v[200:203]
    ds_read_b128 v[104:107], v8 offset:18432
    v_mfma_f32_16x16x32_bf16 v[204:207], v[84:87], v[32:35], v[204:207]
    ds_read_b128 v[108:111], v8 offset:20480
    v_mfma_f32_16x16x32_bf16 v[208:211], v[88:91], v[32:35], v[208:211]
    ds_read_b128 v[112:115], v8 offset:22528
    v_mfma_f32_16x16x32_bf16 v[212:215], v[84:87], v[36:39], v[212:215]
    ds_read_b128 v[116:119], v8 offset:24576
    v_mfma_f32_16x16x32_bf16 v[216:219], v[88:91], v[36:39], v[216:219]
    ds_read_b128 v[120:123], v8 offset:26624
    v_mfma_f32_16x16x32_bf16 v[220:223], v[84:87], v[40:43], v[220:223]
    ds_read_b128 v[124:127], v8 offset:28672
    v_mfma_f32_16x16x32_bf16 v[224:227], v[88:91], v[40:43], v[224:227]
    ds_read_b128 v[128:131], v8 offset:30720
    v_mfma_f32_16x16x32_bf16 v[228:231], v[84:87], v[44:47], v[228:231]
    ds_read_b64_tr_b16 v[172:173], v12 offset:57344
    v_mfma_f32_16x16x32_bf16 v[232:235], v[88:91], v[44:47], v[232:235]
    ds_read_b64_tr_b16 v[174:175], v12 offset:58368
    v_mfma_f32_16x16x32_bf16 v[236:239], v[84:87], v[48:51], v[236:239]
    ds_read_b64_tr_b16 v[176:177], v13 offset:57344
    v_mfma_f32_16x16x32_bf16 v[240:243], v[88:91], v[48:51], v[240:243]
    ds_read_b64_tr_b16 v[178:179], v13 offset:58368
    v_mfma_f32_16x16x32_bf16 v[180:183], v[92:95], v[52:55], v[180:183]
    ds_read_b128 v[132:135], v9 offset:16384
    v_mfma_f32_16x16x32_bf16 v[184:187], v[96:99], v[52:55], v[184:187]
    ds_read_b128 v[136:139], v9 offset:18432
    v_mfma_f32_16x16x32_bf16 v[188:191], v[92:95], v[56:59], v[188:191]
    ds_read_b128 v[140:143], v9 offset:20480
    v_mfma_f32_16x16x32_bf16 v[192:195], v[96:99], v[56:59], v[192:195]
    ds_read_b128 v[144:147], v9 offset:22528
    v_mfma_f32_16x16x32_bf16 v[196:199], v[92:95], v[60:63], v[196:199]
    ds_read_b128 v[148:151], v9 offset:24576
    v_mfma_f32_16x16x32_bf16 v[200:203], v[96:99], v[60:63], v[200:203]
    ds_read_b128 v[152:155], v9 offset:26624
    v_mfma_f32_16x16x32_bf16 v[204:207], v[92:95], v[64:67], v[204:207]
    ds_read_b128 v[156:159], v9 offset:28672
    v_mfma_f32_16x16x32_bf16 v[208:211], v[96:99], v[64:67], v[208:211]
    ds_read_b128 v[160:163], v9 offset:30720
    v_mfma_f32_16x16x32_bf16 v[212:215], v[92:95], v[68:71], v[212:215]
    v_mfma_f32_16x16x32_bf16 v[216:219], v[96:99], v[68:71], v[216:219]
    v_mfma_f32_16x16x32_bf16 v[220:223], v[92:95], v[72:75], v[220:223]
    v_mfma_f32_16x16x32_bf16 v[224:227], v[96:99], v[72:75], v[224:227]
    v_mfma_f32_16x16x32_bf16 v[228:231], v[92:95], v[76:79], v[228:231]
    v_mfma_f32_16x16x32_bf16 v[232:235], v[96:99], v[76:79], v[232:235]
    v_mfma_f32_16x16x32_bf16 v[236:239], v[92:95], v[80:83], v[236:239]
    v_mfma_f32_16x16x32_bf16 v[240:243], v[96:99], v[80:83], v[240:243]
    s_waitcnt lgkmcnt(0)
    s_barrier
    v_mfma_f32_16x16x32_bf16 v[180:183], v[164:167], v[100:103], v[180:183]
    ds_read_b64_tr_b16 v[84:85], v12 offset:0
    v_mfma_f32_16x16x32_bf16 v[184:187], v[168:171], v[100:103], v[184:187]
    ds_read_b64_tr_b16 v[86:87], v12 offset:1024
    v_mfma_f32_16x16x32_bf16 v[188:191], v[164:167], v[104:107], v[188:191]
    ds_read_b64_tr_b16 v[88:89], v13 offset:0
    v_mfma_f32_16x16x32_bf16 v[192:195], v[168:171], v[104:107], v[192:195]
    ds_read_b64_tr_b16 v[90:91], v13 offset:1024
    v_mfma_f32_16x16x32_bf16 v[196:199], v[164:167], v[108:111], v[196:199]
    ds_read_b128 v[20:23], v8 offset:32768
    v_mfma_f32_16x16x32_bf16 v[200:203], v[168:171], v[108:111], v[200:203]
    ds_read_b128 v[24:27], v8 offset:34816
    v_mfma_f32_16x16x32_bf16 v[204:207], v[164:167], v[112:115], v[204:207]
    ds_read_b128 v[28:31], v8 offset:36864
    v_mfma_f32_16x16x32_bf16 v[208:211], v[168:171], v[112:115], v[208:211]
    ds_read_b128 v[32:35], v8 offset:38912
    v_mfma_f32_16x16x32_bf16 v[212:215], v[164:167], v[116:119], v[212:215]
    ds_read_b128 v[36:39], v8 offset:40960
    v_mfma_f32_16x16x32_bf16 v[216:219], v[168:171], v[116:119], v[216:219]
    ds_read_b128 v[40:43], v8 offset:43008
    v_mfma_f32_16x16x32_bf16 v[220:223], v[164:167], v[120:123], v[220:223]
    ds_read_b128 v[44:47], v8 offset:45056
    v_mfma_f32_16x16x32_bf16 v[224:227], v[168:171], v[120:123], v[224:227]
    ds_read_b128 v[48:51], v8 offset:47104
    v_mfma_f32_16x16x32_bf16 v[228:231], v[164:167], v[124:127], v[228:231]
    ds_read_b64_tr_b16 v[92:93], v12 offset:8192
    v_mfma_f32_16x16x32_bf16 v[232:235], v[168:171], v[124:127], v[232:235]
    ds_read_b64_tr_b16 v[94:95], v12 offset:9216
    v_mfma_f32_16x16x32_bf16 v[236:239], v[164:167], v[128:131], v[236:239]
    ds_read_b64_tr_b16 v[96:97], v13 offset:8192
    v_mfma_f32_16x16x32_bf16 v[240:243], v[168:171], v[128:131], v[240:243]
    ds_read_b64_tr_b16 v[98:99], v13 offset:9216
    v_mfma_f32_16x16x32_bf16 v[180:183], v[172:175], v[132:135], v[180:183]
    ds_read_b128 v[52:55], v9 offset:32768
    v_mfma_f32_16x16x32_bf16 v[184:187], v[176:179], v[132:135], v[184:187]
    ds_read_b128 v[56:59], v9 offset:34816
    v_mfma_f32_16x16x32_bf16 v[188:191], v[172:175], v[136:139], v[188:191]
    ds_read_b128 v[60:63], v9 offset:36864
    v_mfma_f32_16x16x32_bf16 v[192:195], v[176:179], v[136:139], v[192:195]
    ds_read_b128 v[64:67], v9 offset:38912
    v_mfma_f32_16x16x32_bf16 v[196:199], v[172:175], v[140:143], v[196:199]
    ds_read_b128 v[68:71], v9 offset:40960
    v_mfma_f32_16x16x32_bf16 v[200:203], v[176:179], v[140:143], v[200:203]
    ds_read_b128 v[72:75], v9 offset:43008
    v_mfma_f32_16x16x32_bf16 v[204:207], v[172:175], v[144:147], v[204:207]
    ds_read_b128 v[76:79], v9 offset:45056
    v_mfma_f32_16x16x32_bf16 v[208:211], v[176:179], v[144:147], v[208:211]
    ds_read_b128 v[80:83], v9 offset:47104
    v_mfma_f32_16x16x32_bf16 v[212:215], v[172:175], v[148:151], v[212:215]
    v_mfma_f32_16x16x32_bf16 v[216:219], v[176:179], v[148:151], v[216:219]
    v_mfma_f32_16x16x32_bf16 v[220:223], v[172:175], v[152:155], v[220:223]
    v_mfma_f32_16x16x32_bf16 v[224:227], v[176:179], v[152:155], v[224:227]
    v_mfma_f32_16x16x32_bf16 v[228:231], v[172:175], v[156:159], v[228:231]
    v_mfma_f32_16x16x32_bf16 v[232:235], v[176:179], v[156:159], v[232:235]
    v_mfma_f32_16x16x32_bf16 v[236:239], v[172:175], v[160:163], v[236:239]
    v_mfma_f32_16x16x32_bf16 v[240:243], v[176:179], v[160:163], v[240:243]
    s_waitcnt lgkmcnt(0)
    s_barrier
    v_mfma_f32_16x16x32_bf16 v[180:183], v[84:87], v[20:23], v[180:183]
    ds_read_b64_tr_b16 v[164:165], v12 offset:16384
    v_mfma_f32_16x16x32_bf16 v[184:187], v[88:91], v[20:23], v[184:187]
    ds_read_b64_tr_b16 v[166:167], v12 offset:17408
    v_mfma_f32_16x16x32_bf16 v[188:191], v[84:87], v[24:27], v[188:191]
    ds_read_b64_tr_b16 v[168:169], v13 offset:16384
    v_mfma_f32_16x16x32_bf16 v[192:195], v[88:91], v[24:27], v[192:195]
    ds_read_b64_tr_b16 v[170:171], v13 offset:17408
    v_mfma_f32_16x16x32_bf16 v[196:199], v[84:87], v[28:31], v[196:199]
    ds_read_b128 v[100:103], v8 offset:49152
    v_mfma_f32_16x16x32_bf16 v[200:203], v[88:91], v[28:31], v[200:203]
    ds_read_b128 v[104:107], v8 offset:51200
    v_mfma_f32_16x16x32_bf16 v[204:207], v[84:87], v[32:35], v[204:207]
    ds_read_b128 v[108:111], v8 offset:53248
    v_mfma_f32_16x16x32_bf16 v[208:211], v[88:91], v[32:35], v[208:211]
    ds_read_b128 v[112:115], v8 offset:55296
    v_mfma_f32_16x16x32_bf16 v[212:215], v[84:87], v[36:39], v[212:215]
    ds_read_b128 v[116:119], v8 offset:57344
    v_mfma_f32_16x16x32_bf16 v[216:219], v[88:91], v[36:39], v[216:219]
    ds_read_b128 v[120:123], v8 offset:59392
    v_mfma_f32_16x16x32_bf16 v[220:223], v[84:87], v[40:43], v[220:223]
    ds_read_b128 v[124:127], v8 offset:61440
    v_mfma_f32_16x16x32_bf16 v[224:227], v[88:91], v[40:43], v[224:227]
    ds_read_b128 v[128:131], v8 offset:63488
    v_mfma_f32_16x16x32_bf16 v[228:231], v[84:87], v[44:47], v[228:231]
    ds_read_b64_tr_b16 v[172:173], v12 offset:24576
    v_mfma_f32_16x16x32_bf16 v[232:235], v[88:91], v[44:47], v[232:235]
    ds_read_b64_tr_b16 v[174:175], v12 offset:25600
    v_mfma_f32_16x16x32_bf16 v[236:239], v[84:87], v[48:51], v[236:239]
    ds_read_b64_tr_b16 v[176:177], v13 offset:24576
    v_mfma_f32_16x16x32_bf16 v[240:243], v[88:91], v[48:51], v[240:243]
    ds_read_b64_tr_b16 v[178:179], v13 offset:25600
    v_mfma_f32_16x16x32_bf16 v[180:183], v[92:95], v[52:55], v[180:183]
    ds_read_b128 v[132:135], v9 offset:49152
    v_mfma_f32_16x16x32_bf16 v[184:187], v[96:99], v[52:55], v[184:187]
    ds_read_b128 v[136:139], v9 offset:51200
    v_mfma_f32_16x16x32_bf16 v[188:191], v[92:95], v[56:59], v[188:191]
    ds_read_b128 v[140:143], v9 offset:53248
    v_mfma_f32_16x16x32_bf16 v[192:195], v[96:99], v[56:59], v[192:195]
    ds_read_b128 v[144:147], v9 offset:55296
    v_mfma_f32_16x16x32_bf16 v[196:199], v[92:95], v[60:63], v[196:199]
    ds_read_b128 v[148:151], v9 offset:57344
    v_mfma_f32_16x16x32_bf16 v[200:203], v[96:99], v[60:63], v[200:203]
    ds_read_b128 v[152:155], v9 offset:59392
    v_mfma_f32_16x16x32_bf16 v[204:207], v[92:95], v[64:67], v[204:207]
    ds_read_b128 v[156:159], v9 offset:61440
    v_mfma_f32_16x16x32_bf16 v[208:211], v[96:99], v[64:67], v[208:211]
    ds_read_b128 v[160:163], v9 offset:63488
    v_mfma_f32_16x16x32_bf16 v[212:215], v[92:95], v[68:71], v[212:215]
    v_mfma_f32_16x16x32_bf16 v[216:219], v[96:99], v[68:71], v[216:219]
    v_mfma_f32_16x16x32_bf16 v[220:223], v[92:95], v[72:75], v[220:223]
    v_mfma_f32_16x16x32_bf16 v[224:227], v[96:99], v[72:75], v[224:227]
    v_mfma_f32_16x16x32_bf16 v[228:231], v[92:95], v[76:79], v[228:231]
    v_mfma_f32_16x16x32_bf16 v[232:235], v[96:99], v[76:79], v[232:235]
    v_mfma_f32_16x16x32_bf16 v[236:239], v[92:95], v[80:83], v[236:239]
    v_mfma_f32_16x16x32_bf16 v[240:243], v[96:99], v[80:83], v[240:243]
    v_mov_b32 v3, s66
    s_cmp_lg_u32 s55, 0
    s_cbranch_scc1 L_nord1
    s_mov_b64 exec, 1
    buffer_load_dwordx2 v[14:15], v3, s[44:47], 0 offen sc1
    s_mov_b64 exec, -1
L_nord1:
    s_waitcnt lgkmcnt(0)
    s_barrier
    v_mfma_f32_16x16x32_bf16 v[180:183], v[164:167], v[100:103], v[180:183]
    ds_read_b64_tr_b16 v[84:85], v12 offset:32768
    v_mfma_f32_16x16x32_bf16 v[184:187], v[168:171], v[100:103], v[184:187]
    ds_read_b64_tr_b16 v[86:87], v12 offset:33792
    v_mfma_f32_16x16x32_bf16 v[188:191], v[164:167], v[104:107], v[188:191]
    ds_read_b64_tr_b16 v[88:89], v13 offset:32768
    v_mfma_f32_16x16x32_bf16 v[192:195], v[168:171], v[104:107], v[192:195]
    ds_read_b64_tr_b16 v[90:91], v13 offset:33792
    v_mfma_f32_16x16x32_bf16 v[196:199], v[164:167], v[108:111], v[196:199]
    ds_read_b128 v[20:23], v10 offset:0
    v_mfma_f32_16x16x32_bf16 v[200:203], v[168:171], v[108:111], v[200:203]
    ds_read_b128 v[24:27], v10 offset:2048
    v_mfma_f32_16x16x32_bf16 v[204:207], v[164:167], v[112:115], v[204:207]
    ds_read_b128 v[28:31], v10 offset:4096
    v_mfma_f32_16x16x32_bf16 v[208:211], v[168:171], v[112:115], v[208:211]
    ds_read_b128 v[32:35], v10 offset:6144
    v_mfma_f32_16x16x32_bf16 v[212:215], v[164:167], v[116:119], v[212:215]
    ds_read_b128 v[36:39], v10 offset:8192
    v_mfma_f32_16x16x32_bf16 v[216:219], v[168:171], v[116:119], v[216:219]
    ds_read_b128 v[40:43], v10 offset:10240
    v_mfma_f32_16x16x32_bf16 v[220:223], v[164:167], v[120:123], v[220:223]
    ds_read_b128 v[44:47], v10 offset:12288
    v_mfma_f32_16x16x32_bf16 v[224:227], v[168:171], v[120:123], v[224:227]
    ds_read_b128 v[48:51], v10 offset:14336
    v_mfma_f32_16x16x32_bf16 v[228:231], v[164:167], v[124:127], v[228:231]
    ds_read_b64_tr_b16 v[92:93], v12 offset:40960
    v_mfma_f32_16x16x32_bf16 v[232:235], v[168:171], v[124:127], v[232:235]
    ds_read_b64_tr_b16 v[94:95], v12 offset:41984
    v_mfma_f32_16x16x32_bf16 v[236:239], v[164:167], v[128:131], v[236:239]
    ds_read_b64_tr_b16 v[96:97], v13 offset:40960
    v_mfma_f32_16x16x32_bf16 v[240:243], v[168:171], v[128:131], v[240:243]
    ds_read_b64_tr_b16 v[98:99], v13 offset:41984
    v_mfma_f32_16x16x32_bf16 v[180:183], v[172:175], v[132:135], v[180:183]
    ds_read_b128 v[52:55], v11 offset:0
    v_mfma_f32_16x16x32_bf16 v[184:187], v[176:179], v[132:135], v[184:187]
    ds_read_b128 v[56:59], v11 offset:2048
    v_mfma_f32_16x16x32_bf16 v[188:191], v[172:175], v[136:139], v[188:191]
    ds_read_b128 v[60:63], v11 offset:4096
    v_mfma_f32_16x16x32_bf16 v[192:195], v[176:179], v[136:139], v[192:195]
    ds_read_b128 v[64:67], v11 offset:6144
    v_mfma_f32_16x16x32_bf16 v[196:199], v[172:175], v[140:143], v[196:199]
    ds_read_b128 v[68:71], v11 offset:8192
    v_mfma_f32_16x16x32_bf16 v[200:203], v[176:179], v[140:143], v[200:203]
    ds_read_b128 v[72:75], v11 offset:10240
    v_mfma_f32_16x16x32_bf16 v[204:207], v[172:175], v[144:147], v[204:207]
    ds_read_b128 v[76:79], v11 offset:12288
    v_mfma_f32_16x16x32_bf16 v[208:211], v[176:179], v[144:147], v[208:211]
    ds_read_b128 v[80:83], v11 offset:14336
    v_mfma_f32_16x16x32_bf16 v[212:215], v[172:175], v[148:151], v[212:215]
    v_mfma_f32_16x16x32_bf16 v[216:219], v[176:179], v[148:151], v[216:219]
    v_mfma_f32_16x16x32_bf16 v[220:223], v[172:175], v[152:155], v[220:223]
    v_mfma_f32_16x16x32_bf16 v[224:227], v[176:179], v[152:155], v[224:227]
    v_mfma_f32_16x16x32_bf16 v[228:231], v[172:175], v[156:159], v[228:231]
    v_mfma_f32_16x16x32_bf16 v[232:235], v[176:179], v[156:159], v[232:235]
    v_mfma_f32_16x16x32_bf16 v[236:239], v[172:175], v[160:163], v[236:239]
    v_mfma_f32_16x16x32_bf16 v[240:243], v[176:179], v[160:163], v[240:243]
    s_waitcnt lgkmcnt(0)
    s_barrier
    v_mfma_f32_16x16x32_bf16 v[180:183], v[84:87], v[20:23], v[180:183]
    ds_read_b64_tr_b16 v[164:165], v12 offset:49152
    v_mfma_f32_16x16x32_bf16 v[184:187], v[88:91], v[20:23], v[184:187]
    ds_read_b64_tr_b16 v[166:167], v12 offset:50176
    v_mfma_f32_16x16x32_bf16 v[188:191], v[84:87], v[24:27], v[188:191]
    ds_read_b64_tr_b16 v[168:169], v13 offset:49152
    v_mfma_f32_16x16x32_bf16 v[192:195], v[88:91], v[24:27], v[192:195]
    ds_read_b64_tr_b16 v[170:171], v13 offset:50176
    v_mfma_f32_16x16x32_bf16 v[196:199], v[84:87], v[28:31], v[196:199]
    ds_read_b128 v[100:103], v10 offset:16384
    v_mfma_f32_16x16x32_bf16 v[200:203], v[88:91], v[28:31], v[200:203]
    ds_read_b128 v[104:107], v10 offset:18432
    v_mfma_f32_16x16x32_bf16 v[204:207], v[84:87], v[32:35], v[204:207]
    ds_read_b128 v[108:111], v10 offset:20480
    v_mfma_f32_16x16x32_bf16 v[208:211], v[88:91], v[32:35], v[208:211]
    ds_read_b128 v[112:115], v10 offset:22528
    v_mfma_f32_16x16x32_bf16 v[212:215], v[84:87], v[36:39], v[212:215]
    ds_read_b128 v[116:119], v10 offset:24576
    v_mfma_f32_16x16x32_bf16 v[216:219], v[88:91], v[36:39], v[216:219]
    ds_read_b128 v[120:123], v10 offset:26624
    v_mfma_f32_16x16x32_bf16 v[220:223], v[84:87], v[40:43], v[220:223]
    ds_read_b128 v[124:127], v10 offset:28672
    v_mfma_f32_16x16x32_bf16 v[224:227], v[88:91], v[40:43], v[224:227]
    ds_read_b128 v[128:131], v10 offset:30720
    v_mfma_f32_16x16x32_bf16 v[228:231], v[84:87], v[44:47], v[228:231]
    ds_read_b64_tr_b16 v[172:173], v12 offset:57344
    v_mfma_f32_16x16x32_bf16 v[232:235], v[88:91], v[44:47], v[232:235]
    ds_read_b64_tr_b16 v[174:175], v12 offset:58368
    v_mfma_f32_16x16x32_bf16 v[236:239], v[84:87], v[48:51], v[236:239]
    ds_read_b64_tr_b16 v[176:177], v13 offset:57344
    v_mfma_f32_16x16x32_bf16 v[240:243], v[88:91], v[48:51], v[240:243]
    ds_read_b64_tr_b16 v[178:179], v13 offset:58368
    v_mfma_f32_16x16x32_bf16 v[180:183], v[92:95], v[52:55], v[180:183]
    ds_read_b128 v[132:135], v11 offset:16384
    v_mfma_f32_16x16x32_bf16 v[184:187], v[96:99], v[52:55], v[184:187]
    ds_read_b128 v[136:139], v11 offset:18432
    v_mfma_f32_16x16x32_bf16 v[188:191], v[92:95], v[56:59], v[188:191]
    ds_read_b128 v[140:143], v11 offset:20480
    v_mfma_f32_16x16x32_bf16 v[192:195], v[96:99], v[56:59], v[192:195]
    ds_read_b128 v[144:147], v11 offset:22528
    v_mfma_f32_16x16x32_bf16 v[196:199], v[92:95], v[60:63], v[196:199]
    ds_read_b128 v[148:151], v11 offset:24576
    v_mfma_f32_16x16x32_bf16 v[200:203], v[96:99], v[60:63], v[200:203]
    ds_read_b128 v[152:155], v11 offset:26624
    v_mfma_f32_16x16x32_bf16 v[204:207], v[92:95], v[64:67], v[204:207]
    ds_read_b128 v[156:159], v11 offset:28672
    v_mfma_f32_16x16x32_bf16 v[208:211], v[96:99], v[64:67], v[208:211]
    ds_read_b128 v[160:163], v11 offset:30720
    v_mfma_f32_16x16x32_bf16 v[212:215], v[92:95], v[68:71], v[212:215]
    v_mfma_f32_16x16x32_bf16 v[216:219], v[96:99], v[68:71], v[216:219]
    v_mfma_f32_16x16x32_bf16 v[220:223], v[92:95], v[72:75], v[220:223]
    v_mfma_f32_16x16x32_bf16 v[224:227], v[96:99], v[72:75], v[224:227]
    v_mfma_f32_16x16x32_bf16 v[228:231], v[92:95], v[76:79], v[228:231]
    v_mfma_f32_16x16x32_bf16 v[232:235], v[96:99], v[76:79], v[232:235]
    v_mfma_f32_16x16x32_bf16 v[236:239], v[92:95], v[80:83], v[236:239]
    v_mfma_f32_16x16x32_bf16 v[240:243], v[96:99], v[80:83], v[240:243]
    s_waitcnt lgkmcnt(0)
    s_barrier
    v_mfma_f32_16x16x32_bf16 v[180:183], v[164:167], v[100:103], v[180:183]
    ds_read_b64_tr_b16 v[84:85], v12 offset:0
    v_mfma_f32_16x16x32_bf16 v[184:187], v[168:171], v[100:103], v[184:187]
    ds_read_b64_tr_b16 v[86:87], v12 offset:1024
    v_mfma_f32_16x16x32_bf16 v[188:191], v[164:167], v[104:107], v[188:191]
    ds_read_b64_tr_b16 v[88:89], v13 offset:0
    v_mfma_f32_16x16x32_bf16 v[192:195], v[168:171], v[104:107], v[192:195]
    ds_read_b64_tr_b16 v[90:91], v13 offset:1024
    v_mfma_f32_16x16x32_bf16 v[196:199], v[164:167], v[108:111], v[196:199]
    ds_read_b128 v[20:23], v8 offset:0
    v_mfma_f32_16x16x32_bf16 v[200:203], v[168:171], v[108:111], v[200:203]
    ds_read_b128 v[24:27], v8 offset:2048
    v_mfma_f32_16x16x32_bf16 v[204:207], v[164:167], v[112:115], v[204:207]
    ds_read_b128 v[28:31], v8 offset:4096
    v_mfma_f32_16x16x32_bf16 v[208:211], v[168:171], v[112:115], v[208:211]
    ds_read_b128 v[32:35], v8 offset:6144
    v_mfma_f32_16x16x32_bf16 v[212:215], v[164:167], v[116:119], v[212:215]
    ds_read_b128 v[36:39], v8 offset:8192
    v_mfma_f32_16x16x32_bf16 v[216:219], v[168:171], v[116:119], v[216:219]
    ds_read_b128 v[40:43], v8 offset:10240
    v_mfma_f32_16x16x32_bf16 v[220:223], v[164:167], v[120:123], v[220:223]
    ds_read_b128 v[44:47], v8 offset:12288
    v_mfma_f32_16x16x32_bf16 v[224:227], v[168:171], v[120:123], v[224:227]
    ds_read_b128 v[48:51], v8 offset:14336
    v_mfma_f32_16x16x32_bf16 v[228:231], v[164:167], v[124:127], v[228:231]
    ds_read_b64_tr_b16 v[92:93], v12 offset:8192
    v_mfma_f32_16x16x32_bf16 v[232:235], v[168:171], v[124:127], v[232:235]
    ds_read_b64_tr_b16 v[94:95], v12 offset:9216
    v_mfma_f32_16x16x32_bf16 v[236:239], v[164:167], v[128:131], v[236:239]
    ds_read_b64_tr_b16 v[96:97], v13 offset:8192
    v_mfma_f32_16x16x32_bf16 v[240:243], v[168:171], v[128:131], v[240:243]
    ds_read_b64_tr_b16 v[98:99], v13 offset:9216
    v_mfma_f32_16x16x32_bf16 v[180:183], v[172:175], v[132:135], v[180:183]
    ds_read_b128 v[52:55], v9 offset:0
    v_mfma_f32_16x16x32_bf16 v[184:187], v[176:179], v[132:135], v[184:187]
    ds_read_b128 v[56:59], v9 offset:2048
    v_mfma_f32_16x16x32_bf16 v[188:191], v[172:175], v[136:139], v[188:191]
    ds_read_b128 v[60:63], v9 offset:4096
    v_mfma_f32_16x16x32_bf16 v[192:195], v[176:179], v[136:139], v[192:195]
    ds_read_b128 v[64:67], v9 offset:6144
    v_mfma_f32_16x16x32_bf16 v[196:199], v[172:175], v[140:143], v[196:199]
    ds_read_b128 v[68:71], v9 offset:8192
    v_mfma_f32_16x16x32_bf16 v[200:203], v[176:179], v[140:143], v[200:203]
    ds_read_b128 v[72:75], v9 offset:10240
    v_mfma_f32_16x16x32_bf16 v[204:207], v[172:175], v[144:147], v[204:207]
    ds_read_b128 v[76:79], v9 offset:12288
    v_mfma_f32_16x16x32_bf16 v[208:211], v[176:179], v[144:147], v[208:211]
    ds_read_b128 v[80:83], v9 offset:14336
    v_mfma_f32_16x16x32_bf16 v[212:215], v[172:175], v[148:151], v[212:215]
    v_mfma_f32_16x16x32_bf16 v[216:219], v[176:179], v[148:151], v[216:219]
    v_mfma_f32_16x16x32_bf16 v[220:223], v[172:175], v[152:155], v[220:223]
    v_mfma_f32_16x16x32_bf16 v[224:227], v[176:179], v[152:155], v[224:227]
    v_mfma_f32_16x16x32_bf16 v[228:231], v[172:175], v[156:159], v[228:231]
    v_mfma_f32_16x16x32_bf16 v[232:235], v[176:179], v[156:159], v[232:235]
    v_mfma_f32_16x16x32_bf16 v[236:239], v[172:175], v[160:163], v[236:239]
    v_mfma_f32_16x16x32_bf16 v[240:243], v[176:179], v[160:163], v[240:243]
    s_waitcnt lgkmcnt(0)
    s_barrier
    v_mfma_f32_16x16x32_bf16 v[180:183], v[84:87], v[20:23], v[180:183]
    v_mfma_f32_16x16x32_bf16 v[184:187], v[88:91], v[20:23], v[184:187]
    v_mfma_f32_16x16x32_bf16 v[180:183], v[92:95], v[52:55], v[180:183]
    v_mfma_f32_16x16x32_bf16 v[184:187], v[96:99], v[52:55], v[184:187]
    v_mfma_f32_16x16x32_bf16 v[188:191], v[84:87], v[24:27], v[188:191]
    v_mfma_f32_16x16x32_bf16 v[192:195], v[88:91], v[24:27], v[192:195]
    v_mfma_f32_16x16x32_bf16 v[188:191], v[92:95], v[56:59], v[188:191]
    v_mfma_f32_16x16x32_bf16 v[192:195], v[96:99], v[56:59], v[192:195]
    v_mfma_f32_16x16x32_bf16 v[196:199], v[84:87], v[28:31], v[196:199]
    v_mfma_f32_16x16x32_bf16 v[200:203], v[88:91], v[28:31], v[200:203]
    v_mfma_f32_16x16x32_bf16 v[196:199], v[92:95], v[60:63], v[196:199]
    v_mfma_f32_16x16x32_bf16 v[200:203], v[96:99], v[60:63], v[200:203]
    s_add_u32 s62, s54, 1
    s_and_b32 s62, s62, 7
    s_add_u32 s61, s62, s66
    s_lshl_b32 s61, s61, 3
    s_add_u32 s61, s61, s54
    s_mul_i32 s61, s61, 6144
    v_add_u32 v183, 0x80, v183
    v_perm_b32 v180, v180, v183, s92
    v_perm_b32 v181, v181, v183, s93
    v_perm_b32 v182, v182, v183, s94
    buffer_store_dwordx3 v[180:182], v2, s[40:43], s61 offen offset:0 sc1
    v_add_u32 v187, 0x80, v187
    v_perm_b32 v184, v184, v187, s92
    v_perm_b32 v185, v185, v187, s93
    v_perm_b32 v186, v186, v187, s94
    buffer_store_dwordx3 v[184:186], v2, s[40:43], s61 offen offset:768 sc1
    v_mfma_f32_16x16x32_bf16 v[204:207], v[84:87], v[32:35], v[204:207]
    v_mfma_f32_16x16x32_bf16 v[208:211], v[88:91], v[32:35], v[208:211]
    v_mfma_f32_16x16x32_bf16 v[204:207], v[92:95], v[64:67], v[204:207]
    v_mfma_f32_16x16x32_bf16 v[208:211], v[96:99], v[64:67], v[208:211]
    s_add_u32 s62, s54, 2
    s_and_b32 s62, s62, 7
    s_add_u32 s61, s62, s66
    s_lshl_b32 s61, s61, 3
    s_add_u32 s61, s61, s54
    s_mul_i32 s61, s61, 6144
    v_add_u32 v191, 0x80, v191
    v_perm_b32 v188, v188, v191, s92
    v_perm_b32 v189, v189, v191, s93
    v_perm_b32 v190, v190, v191, s94
    buffer_store_dwordx3 v[188:190], v2, s[40:43], s61 offen offset:0 sc1
    v_add_u32 v195, 0x80, v195
    v_perm_b32 v192, v192, v195, s92
    v_perm_b32 v193, v193, v195, s93
    v_perm_b32 v194, v194, v195, s94
    buffer_store_dwordx3 v[192:194], v2, s[40:43], s61 offen offset:768 sc1
    v_mfma_f32_16x16x32_bf16 v[212:215], v[84:87], v[36:39], v[212:215]
    v_mfma_f32_16x16x32_bf16 v[216:219], v[88:91], v[36:39], v[216:219]
    v_mfma_f32_16x16x32_bf16 v[212:215], v[92:95], v[68:71], v[212:215]
    v_mfma_f32_16x16x32_bf16 v[216:219], v[96:99], v[68:71], v[216:219]
    s_add_u32 s62, s54, 3
    s_and_b32 s62, s62, 7
    s_add_u32 s61, s62, s66
    s_lshl_b32 s61, s61, 3
    s_add_u32 s61, s61, s54
    s_mul_i32 s61, s61, 6144
    v_add_u32 v199, 0x80, v199
    v_perm_b32 v196, v196, v199, s92
    v_perm_b32 v197, v197, v199, s93
    v_perm_b32 v198, v198, v199, s94
    buffer_store_dwordx3 v[196:198], v2, s[40:43], s61 offen offset:0 sc1
    v_add_u32 v203, 0x80, v203
    v_perm_b32 v200, v200, v203, s92
    v_perm_b32 v201, v201, v203, s93
    v_perm_b32 v202, v202, v203, s94
    buffer_store_dwordx3 v[200:202], v2, s[40:43], s61 offen offset:768 sc1
    v_mfma_f32_16x16x32_bf16 v[220:223], v[84:87], v[40:43], v[220:223]
    v_mfma_f32_16x16x32_bf16 v[224:227], v[88:91], v[40:43], v[224:227]
    v_mfma_f32_16x16x32_bf16 v[220:223], v[92:95], v[72:75], v[220:223]
    v_mfma_f32_16x16x32_bf16 v[224:227], v[96:99], v[72:75], v[224:227]
    s_add_u32 s62, s54, 4
    s_and_b32 s62, s62, 7
    s_add_u32 s61, s62, s66
    s_lshl_b32 s61, s61, 3
    s_add_u32 s61, s61, s54
    s_mul_i32 s61, s61, 6144
    v_add_u32 v207, 0x80, v207
    v_perm_b32 v204, v204, v207, s92
    v_perm_b32 v205, v205, v207, s93
    v_perm_b32 v206, v206, v207, s94
    buffer_store_dwordx3 v[204:206], v2, s[40:43], s61 offen offset:0 sc1
    v_add_u32 v211, 0x80, v211
    v_perm_b32 v208, v208, v211, s92
    v_perm_b32 v209, v209, v211, s93
    v_perm_b32 v210, v210, v211, s94
    buffer_store_dwordx3 v[208:210], v2, s[40:43], s61 offen offset:768 sc1
    v_mfma_f32_16x16x32_bf16 v[228:231], v[84:87], v[44:47], v[228:231]
    v_mfma_f32_16x16x32_bf16 v[232:235], v[88:91], v[44:47], v[232:235]
    v_mfma_f32_16x16x32_bf16 v[228:231], v[92:95], v[76:79], v[228:231]
    v_mfma_f32_16x16x32_bf16 v[232:235], v[96:99], v[76:79], v[232:235]
    s_add_u32 s62, s54, 5
    s_and_b32 s62, s62, 7
    s_add_u32 s61, s62, s66
    s_lshl_b32 s61, s61, 3
    s_add_u32 s61, s61, s54
    s_mul_i32 s61, s61, 6144
    v_add_u32 v215, 0x80, v215
    v_perm_b32 v212, v212, v215, s92
    v_perm_b32 v213, v213, v215, s93
    v_perm_b32 v214, v214, v215, s94
    buffer_store_dwordx3 v[212:214], v2, s[40:43], s61 offen offset:0 sc1
    v_add_u32 v219, 0x80, v219
    v_perm_b32 v216, v216, v219, s92
    v_perm_b32 v217, v217, v219, s93
    v_perm_b32 v218, v218, v219, s94
    buffer_store_dwordx3 v[216:218], v2, s[40:43], s61 offen offset:768 sc1
    v_mfma_f32_16x16x32_bf16 v[236:239], v[84:87], v[48:51], v[236:239]
    v_mfma_f32_16x16x32_bf16 v[240:243], v[88:91], v[48:51], v[240:243]
    v_mfma_f32_16x16x32_bf16 v[236:239], v[92:95], v[80:83], v[236:239]
    v_mfma_f32_16x16x32_bf16 v[240:243], v[96:99], v[80:83], v[240:243]
    s_add_u32 s62, s54, 6
    s_and_b32 s62, s62, 7
    s_add_u32 s61, s62, s66
    s_lshl_b32 s61, s61, 3
    s_add_u32 s61, s61, s54
    s_mul_i32 s61, s61, 6144
    v_add_u32 v223, 0x80, v223
    v_perm_b32 v220, v220, v223, s92
    v_perm_b32 v221, v221, v223, s93
    v_perm_b32 v222, v222, v223, s94
    buffer_store_dwordx3 v[220:222], v2, s[40:43], s61 offen offset:0 sc1
    v_add_u32 v227, 0x80, v227
    v_perm_b32 v224, v224, v227, s92
    v_perm_b32 v225, v225, v227, s93
    v_perm_b32 v226, v226, v227, s94
    buffer_store_dwordx3 v[224:226], v2, s[40:43], s61 offen offset:768 sc1
    s_mov_b32 s67, 0
    s_mov_b32 s92, 0x07060501
    s_mov_b32 s93, 0x07060502
    s_mov_b32 s94, 0x07060503
    s_add_u32 s62, s54, 7
    s_and_b32 s62, s62, 7
    s_add_u32 s61, s62, s66
    s_lshl_b32 s61, s61, 3
    s_add_u32 s61, s61, s54
    s_mul_i32 s61, s61, 6144
    v_add_u32 v231, 0x80, v231
    v_perm_b32 v228, v228, v231, s92
    v_perm_b32 v229, v229, v231, s93
    v_perm_b32 v230, v230, v231, s94
    buffer_store_dwordx3 v[228:230], v2, s[40:43], s61 offen offset:0 sc1
    v_add_u32 v235, 0x80, v235
    v_perm_b32 v232, v232, v235, s92
    v_perm_b32 v233, v233, v235, s93
    v_perm_b32 v234, v234, v235, s94
    buffer_store_dwordx3 v[232:234], v2, s[40:43], s61 offen offset:768 sc1
    v_lshlrev_b32 v4, 4, v1
    s_lshl_b32 s61, s55, 11
    v_add_u32 v4, s61, v4
    ds_write_b128 v4, v[236:239] offset:0
    ds_write_b128 v4, v[240:243] offset:1024
    s_cmp_lg_u32 s55, 0
    s_cbranch_scc1 L_rdyok
    s_waitcnt vmcnt(14)
L_rdychk:
    v_and_b32 v4, v14, v15
    s_nop 0
    v_readfirstlane_b32 s61, v4
    s_cmp_eq_u32 s61, 0x01010101
    s_cbranch_scc1 L_rdyok
    s_add_u32 s67, s67, 1
    s_cmp_gt_u32 s67, 0x8000
    s_cbranch_scc1 L_rdyok
    s_sleep 2
    buffer_load_dwordx2 v[14:15], v3, s[44:47], 0 offen sc1
    s_waitcnt vmcnt(0)
    s_branch L_rdychk
L_rdyok:
    s_waitcnt vmcnt(0) lgkmcnt(0)
    s_barrier
    s_sub_u32 s59, s55, 1
    s_cmp_ge_u32 s59, 1
    s_cbranch_scc1 L_notpoller
    s_lshl_b32 s59, s63, 3
    s_add_u32 s59, s59, s54
    s_mul_i32 s59, s59, 6144
    v_lshlrev_b32 v3, 7, v1
    v_add_u32 v3, s59, v3
    v_lshlrev_b32 v4, 2, v1
    v_add_u32 v4, 0x4400, v4
    s_lshl_b32 s65, 1, s54
    s_mov_b32 exec_hi, 0
L_cpoll:
    s_andn2_b32 exec_lo, 0xff, s65
    v_mov_b32 v5, 0
    buffer_atomic_or v5, v3, s[40:43], 0 offen sc0 sc1
    s_add_u32 s67, s67, 1
    s_cmp_gt_u32 s67, 0x20000
    s_cbranch_scc1 L_end
    s_waitcnt vmcnt(0)
    v_cmp_ne_u32 vcc, 0, v5
    s_nop 1
    s_mov_b32 exec_lo, vcc_lo
    ds_write_b32 v4, v5
    s_or_b32 s65, s65, vcc_lo
    s_cmp_lg_u32 s65, 0xff
    s_cbranch_scc1 L_cpoll
    s_endpgm
L_notpoller:
    s_cmp_lg_u32 s55, 0
    s_cbranch_scc1 L_end
    s_mov_b64 exec, 0x7f
    buffer_store_dword v6, v16, s[40:43], 0 offen sc1
    s_mov_b64 exec, -1
L_end:
    s_endpgm
.section .rodata,"a"
.p2align 6
.amdhsa_kernel standalone__deep_cross_wide_deep__recsys_kernel
  .amdhsa_next_free_vgpr 248
  .amdhsa_next_free_sgpr 102
  .amdhsa_accum_offset 248
  .amdhsa_group_segment_fixed_size 0
  .amdhsa_kernarg_size 96
  .amdhsa_user_sgpr_count 2
  .amdhsa_user_sgpr_kernarg_segment_ptr 1
  .amdhsa_system_sgpr_workgroup_id_x 1
  .amdhsa_float_denorm_mode_32 3
.end_amdhsa_kernel
```
